```python
import torch

def _softmax(x, axis=-1):
    return torch.softmax(x, dim=axis)
def _gelu(x):
    return torch.nn.functional.gelu(x, approximate="tanh")
def _silu(x):
    return torch.nn.functional.silu(x)
def _sigmoid(x):
    return torch.sigmoid(x)
def _layernorm(x, axis=-1, eps=1e-5):
    m = x.mean(dim=axis, keepdim=True)
    v = x.var(dim=axis, keepdim=True, unbiased=False)
    return (x - m) / torch.sqrt(v + eps)
def _scatter_add(tgt, idx, src, axis=0):
    return tgt.clone().index_add_(axis, idx, src)
def _segment_sum(src, seg, n):
    out = torch.zeros((n,) + src.shape[1:], dtype=src.dtype)
    return out.index_add_(0, seg, src)
def _pad(x, pw):
    flat = tuple(v for pair in reversed(pw) for v in pair)
    return torch.nn.functional.pad(x, flat)

kernel_name = 'standalone__gqa_block_cached__near_ridge'

def setup_inputs():

    _w = (lambda a: (lambda t: t.to(torch.bfloat16) if t.is_floating_point() else t)(torch.as_tensor(a)))
    B, Sq, D = 8, 64, 512
    Hq, Hkv, Sk, Dh = 32, 8, 2048, 128
    assert Hq % Hkv == 0, (Hq, Hkv)
    return {
        "x": _w((lambda *s: torch.randn(*s, dtype=torch.bfloat16) * 0.8)(B, Sq, D)),
        "k_cache": _w((lambda *s: torch.randn(*s, dtype=torch.bfloat16) * 0.8)(B, Hkv, Sk, Dh)),
        "v_cache": _w((lambda *s: torch.randn(*s, dtype=torch.bfloat16) * 0.05)(B, Hkv, Sk, Dh)),
        "wq": _w((lambda *s: torch.randn(*s, dtype=torch.bfloat16) * 0.8)(D, Hq * Dh) * (D ** -0.5)),
        "wo": _w((lambda *s: torch.randn(*s, dtype=torch.bfloat16) * 0.05)(Hq * Dh, D) * ((Hq * Dh) ** -0.5)),
    }

def reference(x, k_cache, v_cache, wq, wo):
    B, Sq, D = x.shape
    Hq, Dh = 32, 128
    Hkv = k_cache.shape[1]
    rep = Hq // Hkv
    q = (lambda x, *d: x.permute(*d))((x @ wq).reshape(B, Sq, Hq, Dh), 0, 2, 1, 3)
    k = (lambda x, n, axis: torch.repeat_interleave(x, n, dim=axis))(k_cache, rep, axis=1)
    v = (lambda x, n, axis: torch.repeat_interleave(x, n, dim=axis))(v_cache, rep, axis=1)
    scores = torch.einsum("bhqd,bhkd->bhqk", q, k) * (Dh ** -0.5)
    p = _softmax(scores, axis=-1)
    o = torch.einsum("bhqk,bhkd->bhqd", p, v)
    return (lambda x, *d: x.permute(*d))(o, 0, 2, 1, 3).reshape(B, Sq, Hq * Dh) @ wo
```

```asm
; @launch grid=(256,1,1) block=(256,1,1) lds=163840
.amdgcn_target "amdgcn-amd-amdhsa--gfx950"
.text
.globl standalone__gqa_block_cached__near_ridge_kernel
.p2align 8
.type standalone__gqa_block_cached__near_ridge_kernel,@function
standalone__gqa_block_cached__near_ridge_kernel:
  s_cmp_ge_u32 s2, 256
  s_cbranch_scc1 L_done
  s_load_dwordx16 s[16:31], s[0:1], 0
  s_memrealtime s[64:65]
  s_getreg_b32 s10, hwreg(HW_REG_XCC_ID)
  v_lshrrev_b32 v1, 6, v0
  v_and_b32 v0, 63, v0
  s_and_b32 s4, s2, 7
  v_readfirstlane_b32 s3, v1
  s_lshr_b32 s15, s2, 3
  s_lshr_b32 s5, s15, 2
  s_and_b32 s6, s15, 3
  s_and_b32 s10, s10, 7
  s_lshl_b32 s11, s5, 3
  s_add_u32 s11, s11, s4
  v_lshlrev_b32 v14, 4, v0
  v_lshlrev_b32 v15, 2, v0
  s_lshl_b32 s12, s3, 11
  v_lshrrev_b32 v2, 4, v0
  v_and_b32 v3, 15, v0
  v_lshrrev_b32 v4, 3, v0
  v_and_b32 v5, 7, v0
  v_xor_b32 v6, v5, v2
  v_lshlrev_b32 v6, 4, v6
  v_lshl_add_u32 v224, v4, 10, v6
  v_add_u32 v7, 4, v2
  v_xor_b32 v6, v5, v7
  v_lshlrev_b32 v6, 4, v6
  v_lshl_add_u32 v225, v4, 10, v6
  v_lshlrev_b32 v6, 2, v2
  v_xor_b32 v6, v6, v3
  v_lshlrev_b32 v6, 4, v6
  v_lshl_add_u32 v226, v2, 13, v6
  v_lshlrev_b32 v8, 7, v5
  s_waitcnt lgkmcnt(0)
  s_lshl_b32 s66, s15, 2
  s_add_u32 s66, s66, s3
  s_mov_b32 s44, s22
  s_mov_b32 s45, s23
  s_mov_b32 s46, 0x400000
  s_mov_b32 s47, 0x20000
  s_mov_b32 s40, s16
  s_mov_b32 s41, s17
  s_mov_b32 s42, 0x80000
  s_mov_b32 s43, 0x20000
  s_mov_b32 s52, s30
  s_mov_b32 s53, s31
  s_mov_b32 s54, 0x2400000
  s_mov_b32 s55, 0x20000
  s_mov_b32 s60, s28
  s_mov_b32 s61, s29
  s_mov_b32 s62, 0x100
  s_mov_b32 s63, 0x20000
  s_mov_b32 s14, s64
  s_cmp_lg_u32 s2, 0
  s_cbranch_scc1 L_nononce
  s_cmp_lg_u32 s3, 0
  s_cbranch_scc1 L_nononce
  s_lshl_b32 s68, s14, 4
  s_or_b32 s68, s68, 0x80000000
  v_mov_b32 v6, s68
  v_mov_b32 v7, 0
  s_mov_b64 exec, 1
  buffer_store_dword v6, v7, s[60:63], 0 offen sc0 sc1
  s_mov_b64 exec, -1
L_nononce:
  s_lshl_b32 s67, s5, 16
  s_add_u32 s40, s16, s67
  s_addc_u32 s41, s17, 0
  s_mov_b32 s42, 0x10000
  s_mov_b32 s43, 0x20000
  s_lshl_b32 s67, s4, 2
  s_add_u32 s67, s67, s6
  s_lshl_b32 s68, s67, 8
  s_add_u32 s44, s22, s68
  s_addc_u32 s45, s23, 0
  s_mov_b32 s46, 0x400000
  s_mov_b32 s47, 0x20000
  s_sub_u32 s46, s46, s68
  s_lshl_b32 s70, s3, 14
  s_lshl_b32 s72, s3, 17
  s_lshl_b32 s73, s3, 12
  s_lshl_b32 s75, s6, 1
  s_add_u32 s75, s75, s5
  s_add_u32 s76, s75, 0
  s_and_b32 s76, s76, 7
  s_lshl_b32 s71, s76, 7
  s_add_u32 s71, s71, s70
  s_lshl_b32 s76, s76, 19
  s_add_u32 s76, s76, s72
  s_add_u32 m0, s73, 32768
  s_add_u32 s74, s76, 0
  buffer_load_dwordx4 v226, s[44:47], s74 offen lds
  s_add_u32 m0, s73, 33792
  s_add_u32 s74, s76, 32768
  buffer_load_dwordx4 v226, s[44:47], s74 offen lds
  s_add_u32 m0, s73, 34816
  s_add_u32 s74, s76, 65536
  buffer_load_dwordx4 v226, s[44:47], s74 offen lds
  s_add_u32 m0, s73, 35840
  s_add_u32 s74, s76, 98304
  buffer_load_dwordx4 v226, s[44:47], s74 offen lds
  s_add_u32 m0, s12, 131072
  s_add_u32 s74, s71, 0
  buffer_load_dwordx4 v224, s[40:43], s74 offen lds
  s_add_u32 m0, s12, 132096
  s_add_u32 s74, s71, 8192
  buffer_load_dwordx4 v225, s[40:43], s74 offen lds
  s_lshl_b32 s64, s5, 5
  s_lshl_b32 s65, s4, 2
  s_add_u32 s64, s64, s65
  s_add_u32 s65, s64, s6
  s_lshl_b32 s65, s65, 14
  s_add_u32 s65, s65, s12
  v_bfe_u32 v4, v0, 4, 1
  v_bfe_u32 v5, v0, 3, 1
  v_and_b32 v6, 7, v0
  v_lshlrev_b32 v4, 13, v4
  v_lshl_add_u32 v4, v5, 10, v4
  v_lshl_add_u32 v233, v6, 7, v4
  s_add_u32 s76, s75, 1
  s_and_b32 s76, s76, 7
  s_lshl_b32 s71, s76, 7
  s_add_u32 s71, s71, s70
  s_lshl_b32 s76, s76, 19
  s_add_u32 s76, s76, s72
  s_add_u32 m0, s73, 49152
  s_add_u32 s74, s76, 0
  buffer_load_dwordx4 v226, s[44:47], s74 offen lds
  s_add_u32 m0, s73, 50176
  s_add_u32 s74, s76, 32768
  buffer_load_dwordx4 v226, s[44:47], s74 offen lds
  s_add_u32 m0, s73, 51200
  s_add_u32 s74, s76, 65536
  buffer_load_dwordx4 v226, s[44:47], s74 offen lds
  s_add_u32 m0, s73, 52224
  s_add_u32 s74, s76, 98304
  buffer_load_dwordx4 v226, s[44:47], s74 offen lds
  s_add_u32 m0, s12, 139264
  s_add_u32 s74, s71, 0
  buffer_load_dwordx4 v224, s[40:43], s74 offen lds
  s_add_u32 m0, s12, 140288
  s_add_u32 s74, s71, 8192
  buffer_load_dwordx4 v225, s[40:43], s74 offen lds
  s_lshl_b32 s66, s3, 2
  v_bfe_u32 v4, v0, 4, 1
  v_and_b32 v5, 3, v0
  v_and_b32 v6, 1, v5
  v_lshrrev_b32 v5, 1, v5
  v_lshl_add_u32 v6, v4, 1, v6
  v_add_u32 v6, s66, v6
  v_bfe_u32 v4, v0, 2, 2
  v_lshlrev_b32 v7, 2, v4
  v_xor_b32 v6, v6, v7
  v_lshlrev_b32 v6, 4, v6
  v_lshl_add_u32 v6, v5, 3, v6
  v_lshrrev_b32 v7, 5, v0
  v_lshl_add_u32 v7, v7, 3, v4
  v_lshl_add_u32 v227, v7, 8, v6
  v_add_u32 v227, 0x8000, v227
  v_add_u32 v228, 0x10000, v227
  v_and_b32 v6, 31, v0
  v_lshrrev_b32 v7, 5, v0
  v_bfe_u32 v8, v0, 1, 3
  v_add_u32 v1, 0, v7
  v_xor_b32 v1, v1, v8
  v_lshlrev_b32 v1, 4, v1
  v_lshl_add_u32 v229, v6, 7, v1
  v_add_u32 v229, 0x20000, v229
  v_add_u32 v1, 2, v7
  v_xor_b32 v1, v1, v8
  v_lshlrev_b32 v1, 4, v1
  v_lshl_add_u32 v230, v6, 7, v1
  v_add_u32 v230, 0x20000, v230
  v_add_u32 v1, 4, v7
  v_xor_b32 v1, v1, v8
  v_lshlrev_b32 v1, 4, v1
  v_lshl_add_u32 v231, v6, 7, v1
  v_add_u32 v231, 0x20000, v231
  v_add_u32 v1, 6, v7
  v_xor_b32 v1, v1, v8
  v_lshlrev_b32 v1, 4, v1
  v_lshl_add_u32 v232, v6, 7, v1
  v_add_u32 v232, 0x20000, v232
  s_add_u32 s76, s75, 2
  s_and_b32 s76, s76, 7
  s_lshl_b32 s71, s76, 7
  s_add_u32 s71, s71, s70
  s_lshl_b32 s76, s76, 19
  s_add_u32 s76, s76, s72
  s_add_u32 m0, s73, 98304
  s_add_u32 s74, s76, 0
  buffer_load_dwordx4 v226, s[44:47], s74 offen lds
  s_add_u32 m0, s73, 99328
  s_add_u32 s74, s76, 32768
  buffer_load_dwordx4 v226, s[44:47], s74 offen lds
  s_add_u32 m0, s73, 100352
  s_add_u32 s74, s76, 65536
  buffer_load_dwordx4 v226, s[44:47], s74 offen lds
  s_add_u32 m0, s73, 101376
  s_add_u32 s74, s76, 98304
  buffer_load_dwordx4 v226, s[44:47], s74 offen lds
  s_add_u32 m0, s12, 147456
  s_add_u32 s74, s71, 0
  buffer_load_dwordx4 v224, s[40:43], s74 offen lds
  s_add_u32 m0, s12, 148480
  s_add_u32 s74, s71, 8192
  buffer_load_dwordx4 v225, s[40:43], s74 offen lds
  s_lshl_b32 s67, s11, 19
  s_lshl_b32 s68, s6, 17
  s_add_u32 s67, s67, s68
  s_add_u32 s32, s18, s67
  s_addc_u32 s33, s19, 0
  s_mov_b32 s34, 0x20000
  s_mov_b32 s35, 0x20000
  s_add_u32 s36, s20, s67
  s_addc_u32 s37, s21, 0
  s_mov_b32 s38, 0x20000
  s_mov_b32 s39, 0x20000
  s_lshl_b32 s66, s3, 3
  v_add_u32 v4, s66, v2
  v_add_u32 v5, 0, v4
  v_and_b32 v5, 15, v5
  v_xor_b32 v5, v5, v3
  v_lshlrev_b32 v5, 4, v5
  v_lshl_add_u32 v10, v4, 8, v5
  v_add_u32 v4, s66, v2
  v_add_u32 v5, 4, v4
  v_and_b32 v5, 15, v5
  v_xor_b32 v5, v5, v3
  v_lshlrev_b32 v5, 4, v5
  v_lshl_add_u32 v11, v4, 8, v5
  v_lshlrev_b32 v5, 2, v2
  v_xor_b32 v5, v5, v3
  v_lshlrev_b32 v5, 4, v5
  v_lshl_add_u32 v12, v4, 8, v5
  v_lshl_add_u32 v13, v4, 10, v5
  v_mov_b32 v5, 0
  s_add_u32 s66, s65, 0
  buffer_load_dword v9, v233, s[52:55], s66 offen
  s_lshl_b32 s66, s11, 7
  s_add_u32 s67, s66, 34603008
  buffer_load_dword v9, v5, s[52:55], s67 offen
  buffer_load_dword v9, v5, s[32:35], 0 offen
  buffer_load_dword v9, v5, s[36:39], 0 offen
  s_waitcnt vmcnt(16)
  s_barrier
  ds_read_b64_tr_b16 v[32:33], v227 offset:0
  ds_read_b64_tr_b16 v[34:35], v227 offset:1024
  ds_read_b128 v[64:67], v229 offset:0
  ds_read_b128 v[68:71], v229 offset:4096
  ds_read_b64_tr_b16 v[36:37], v227 offset:4096
  ds_read_b64_tr_b16 v[38:39], v227 offset:5120
  ds_read_b128 v[72:75], v230 offset:0
  ds_read_b128 v[76:79], v230 offset:4096
  ds_read_b64_tr_b16 v[40:41], v227 offset:8192
  ds_read_b64_tr_b16 v[42:43], v227 offset:9216
  ds_read_b128 v[80:83], v231 offset:0
  ds_read_b128 v[84:87], v231 offset:4096
  ds_read_b64_tr_b16 v[44:45], v227 offset:12288
  ds_read_b64_tr_b16 v[46:47], v227 offset:13312
  ds_read_b128 v[88:91], v232 offset:0
  ds_read_b128 v[92:95], v232 offset:4096
  s_waitcnt vmcnt(10) lgkmcnt(0)
  s_barrier
  v_mfma_f32_32x32x16_bf16 v[128:143], v[32:35], v[64:67], 0
  ds_read_b64_tr_b16 v[48:49], v227 offset:16384
  ds_read_b64_tr_b16 v[50:51], v227 offset:17408
  ds_read_b128 v[96:99], v229 offset:8192
  ds_read_b128 v[100:103], v229 offset:12288
  ds_read_b64_tr_b16 v[52:53], v227 offset:20480
  v_mfma_f32_32x32x16_bf16 v[144:159], v[32:35], v[68:71], 0
  ds_read_b64_tr_b16 v[54:55], v227 offset:21504
  ds_read_b128 v[104:107], v230 offset:8192
  ds_read_b128 v[108:111], v230 offset:12288
  ds_read_b64_tr_b16 v[56:57], v227 offset:24576
  ds_read_b64_tr_b16 v[58:59], v227 offset:25600
  v_mfma_f32_32x32x16_bf16 v[128:143], v[36:39], v[72:75], v[128:143]
  ds_read_b128 v[112:115], v231 offset:8192
  ds_read_b128 v[116:119], v231 offset:12288
  ds_read_b64_tr_b16 v[60:61], v227 offset:28672
  ds_read_b64_tr_b16 v[62:63], v227 offset:29696
  ds_read_b128 v[120:123], v232 offset:8192
  v_mfma_f32_32x32x16_bf16 v[144:159], v[36:39], v[76:79], v[144:159]
  ds_read_b128 v[124:127], v232 offset:12288
  s_add_u32 s76, s75, 3
  s_and_b32 s76, s76, 7
  s_lshl_b32 s71, s76, 7
  s_add_u32 s71, s71, s70
  s_lshl_b32 s76, s76, 19
  v_mfma_f32_32x32x16_bf16 v[128:143], v[40:43], v[80:83], v[128:143]
  s_add_u32 s76, s76, s72
  s_add_u32 m0, s73, 114688
  s_add_u32 s74, s76, 0
  buffer_load_dwordx4 v226, s[44:47], s74 offen lds
  s_add_u32 m0, s73, 115712
  v_mfma_f32_32x32x16_bf16 v[144:159], v[40:43], v[84:87], v[144:159]
  s_add_u32 s74, s76, 32768
  buffer_load_dwordx4 v226, s[44:47], s74 offen lds
  s_add_u32 m0, s73, 116736
  s_add_u32 s74, s76, 65536
  buffer_load_dwordx4 v226, s[44:47], s74 offen lds
  v_mfma_f32_32x32x16_bf16 v[128:143], v[44:47], v[88:91], v[128:143]
  s_add_u32 m0, s73, 117760
  s_add_u32 s74, s76, 98304
  buffer_load_dwordx4 v226, s[44:47], s74 offen lds
  s_add_u32 m0, s12, 155648
  s_add_u32 s74, s71, 0
  v_mfma_f32_32x32x16_bf16 v[144:159], v[44:47], v[92:95], v[144:159]
  buffer_load_dwordx4 v224, s[40:43], s74 offen lds
  s_add_u32 m0, s12, 156672
  s_add_u32 s74, s71, 8192
  buffer_load_dwordx4 v225, s[40:43], s74 offen lds
  v_mov_b32 v5, 0
  buffer_load_dword v8, v5, s[60:63], 0 offen sc1
  s_waitcnt vmcnt(11) lgkmcnt(0)
  s_barrier
  v_mfma_f32_32x32x16_bf16 v[128:143], v[48:51], v[96:99], v[128:143]
  ds_read_b64_tr_b16 v[32:33], v228 offset:0
  ds_read_b64_tr_b16 v[34:35], v228 offset:1024
  ds_read_b128 v[64:67], v229 offset:16384
  ds_read_b128 v[68:71], v229 offset:20480
  ds_read_b64_tr_b16 v[36:37], v228 offset:4096
  v_mfma_f32_32x32x16_bf16 v[144:159], v[48:51], v[100:103], v[144:159]
  ds_read_b64_tr_b16 v[38:39], v228 offset:5120
  ds_read_b128 v[72:75], v230 offset:16384
  ds_read_b128 v[76:79], v230 offset:20480
  ds_read_b64_tr_b16 v[40:41], v228 offset:8192
  ds_read_b64_tr_b16 v[42:43], v228 offset:9216
  v_mfma_f32_32x32x16_bf16 v[128:143], v[52:55], v[104:107], v[128:143]
  ds_read_b128 v[80:83], v231 offset:16384
  ds_read_b128 v[84:87], v231 offset:20480
  ds_read_b64_tr_b16 v[44:45], v228 offset:12288
  ds_read_b64_tr_b16 v[46:47], v228 offset:13312
  ds_read_b128 v[88:91], v232 offset:16384
  v_mfma_f32_32x32x16_bf16 v[144:159], v[52:55], v[108:111], v[144:159]
  ds_read_b128 v[92:95], v232 offset:20480
  s_add_u32 s76, s75, 4
  s_and_b32 s76, s76, 7
  s_lshl_b32 s71, s76, 7
  s_add_u32 s71, s71, s70
  v_mfma_f32_32x32x16_bf16 v[128:143], v[56:59], v[112:115], v[128:143]
  s_lshl_b32 s76, s76, 19
  s_add_u32 s76, s76, s72
  s_add_u32 m0, s73, 32768
  s_add_u32 s74, s76, 0
  buffer_load_dwordx4 v226, s[44:47], s74 offen lds
  v_mfma_f32_32x32x16_bf16 v[144:159], v[56:59], v[116:119], v[144:159]
  s_add_u32 m0, s73, 33792
  s_add_u32 s74, s76, 32768
  buffer_load_dwordx4 v226, s[44:47], s74 offen lds
  s_add_u32 m0, s73, 34816
  s_add_u32 s74, s76, 65536
  v_mfma_f32_32x32x16_bf16 v[128:143], v[60:63], v[120:123], v[128:143]
  buffer_load_dwordx4 v226, s[44:47], s74 offen lds
  s_add_u32 m0, s73, 35840
  s_add_u32 s74, s76, 98304
  buffer_load_dwordx4 v226, s[44:47], s74 offen lds
  s_add_u32 m0, s12, 131072
  v_mfma_f32_32x32x16_bf16 v[144:159], v[60:63], v[124:127], v[144:159]
  s_add_u32 s74, s71, 0
  buffer_load_dwordx4 v224, s[40:43], s74 offen lds
  s_add_u32 m0, s12, 132096
  s_add_u32 s74, s71, 8192
  buffer_load_dwordx4 v225, s[40:43], s74 offen lds
  s_waitcnt vmcnt(7) lgkmcnt(0)
  s_barrier
  v_mfma_f32_32x32x16_bf16 v[128:143], v[32:35], v[64:67], v[128:143]
  ds_read_b64_tr_b16 v[48:49], v228 offset:16384
  ds_read_b64_tr_b16 v[50:51], v228 offset:17408
  ds_read_b128 v[96:99], v229 offset:24576
  ds_read_b128 v[100:103], v229 offset:28672
  ds_read_b64_tr_b16 v[52:53], v228 offset:20480
  v_mfma_f32_32x32x16_bf16 v[144:159], v[32:35], v[68:71], v[144:159]
  ds_read_b64_tr_b16 v[54:55], v228 offset:21504
  ds_read_b128 v[104:107], v230 offset:24576
  ds_read_b128 v[108:111], v230 offset:28672
  ds_read_b64_tr_b16 v[56:57], v228 offset:24576
  ds_read_b64_tr_b16 v[58:59], v228 offset:25600
  v_mfma_f32_32x32x16_bf16 v[128:143], v[36:39], v[72:75], v[128:143]
  ds_read_b128 v[112:115], v231 offset:24576
  ds_read_b128 v[116:119], v231 offset:28672
  ds_read_b64_tr_b16 v[60:61], v228 offset:28672
  ds_read_b64_tr_b16 v[62:63], v228 offset:29696
  ds_read_b128 v[120:123], v232 offset:24576
  v_mfma_f32_32x32x16_bf16 v[144:159], v[36:39], v[76:79], v[144:159]
  ds_read_b128 v[124:127], v232 offset:28672
  s_add_u32 s76, s75, 5
  s_and_b32 s76, s76, 7
  s_lshl_b32 s71, s76, 7
  s_add_u32 s71, s71, s70
  v_mfma_f32_32x32x16_bf16 v[128:143], v[40:43], v[80:83], v[128:143]
  s_lshl_b32 s76, s76, 19
  s_add_u32 s76, s76, s72
  s_add_u32 m0, s73, 49152
  s_add_u32 s74, s76, 0
  buffer_load_dwordx4 v226, s[44:47], s74 offen lds
  v_mfma_f32_32x32x16_bf16 v[144:159], v[40:43], v[84:87], v[144:159]
  s_add_u32 m0, s73, 50176
  s_add_u32 s74, s76, 32768
  buffer_load_dwordx4 v226, s[44:47], s74 offen lds
  s_add_u32 m0, s73, 51200
  s_add_u32 s74, s76, 65536
  v_mfma_f32_32x32x16_bf16 v[128:143], v[44:47], v[88:91], v[128:143]
  buffer_load_dwordx4 v226, s[44:47], s74 offen lds
  s_add_u32 m0, s73, 52224
  s_add_u32 s74, s76, 98304
  buffer_load_dwordx4 v226, s[44:47], s74 offen lds
  s_add_u32 m0, s12, 139264
  v_mfma_f32_32x32x16_bf16 v[144:159], v[44:47], v[92:95], v[144:159]
  s_add_u32 s74, s71, 0
  buffer_load_dwordx4 v224, s[40:43], s74 offen lds
  s_add_u32 m0, s12, 140288
  s_add_u32 s74, s71, 8192
  buffer_load_dwordx4 v225, s[40:43], s74 offen lds
  s_waitcnt vmcnt(6) lgkmcnt(0)
  s_barrier
  s_mov_b32 s14, 65536
  s_branch L_noncechk_3
L_nonce_1:
  buffer_load_dword v8, v5, s[60:63], 0 offen sc1
  s_sub_u32 s14, s14, 1
  s_cbranch_scc1 L_noncex_2
  s_waitcnt vmcnt(0)
L_noncechk_3:
  v_readfirstlane_b32 s8, v8
  s_nop 3
  s_cmp_eq_u32 s8, 0
  s_cbranch_scc1 L_nonce_1
L_noncex_2:
  s_lshl_b32 s66, s11, 7
  s_lshl_b32 s67, s6, 2
  s_add_u32 s66, s66, s67
  s_add_u32 s66, s66, 34701312
  s_cmp_lg_u32 s3, 0
  s_cbranch_scc1 L_hw_4
  s_or_b32 s67, s8, s10
  v_mov_b32 v8, s67
  s_mov_b64 exec, 1
  buffer_store_dword v8, v5, s[52:55], s66 offen sc0 sc1
  s_mov_b64 exec, -1
  s_branch L_hwd_5
L_hw_4:
  buffer_load_dword v9, v5, s[60:63], 0 offen
L_hwd_5:
  v_mfma_f32_32x32x16_bf16 v[128:143], v[48:51], v[96:99], v[128:143]
  ds_read_b64_tr_b16 v[32:33], v227 offset:0
  ds_read_b64_tr_b16 v[34:35], v227 offset:1024
  ds_read_b128 v[64:67], v229 offset:0
  ds_read_b128 v[68:71], v229 offset:4096
  ds_read_b64_tr_b16 v[36:37], v227 offset:4096
  v_mfma_f32_32x32x16_bf16 v[144:159], v[48:51], v[100:103], v[144:159]
  ds_read_b64_tr_b16 v[38:39], v227 offset:5120
  ds_read_b128 v[72:75], v230 offset:0
  ds_read_b128 v[76:79], v230 offset:4096
  ds_read_b64_tr_b16 v[40:41], v227 offset:8192
  ds_read_b64_tr_b16 v[42:43], v227 offset:9216
  v_mfma_f32_32x32x16_bf16 v[128:143], v[52:55], v[104:107], v[128:143]
  ds_read_b128 v[80:83], v231 offset:0
  ds_read_b128 v[84:87], v231 offset:4096
  ds_read_b64_tr_b16 v[44:45], v227 offset:12288
  ds_read_b64_tr_b16 v[46:47], v227 offset:13312
  ds_read_b128 v[88:91], v232 offset:0
  v_mfma_f32_32x32x16_bf16 v[144:159], v[52:55], v[108:111], v[144:159]
  ds_read_b128 v[92:95], v232 offset:4096
  s_add_u32 s76, s75, 6
  s_and_b32 s76, s76, 7
  s_lshl_b32 s71, s76, 7
  s_add_u32 s71, s71, s70
  v_mfma_f32_32x32x16_bf16 v[128:143], v[56:59], v[112:115], v[128:143]
  s_lshl_b32 s76, s76, 19
  s_add_u32 s76, s76, s72
  s_add_u32 m0, s73, 98304
  s_add_u32 s74, s76, 0
  buffer_load_dwordx4 v226, s[44:47], s74 offen lds
  v_mfma_f32_32x32x16_bf16 v[144:159], v[56:59], v[116:119], v[144:159]
  s_add_u32 m0, s73, 99328
  s_add_u32 s74, s76, 32768
  buffer_load_dwordx4 v226, s[44:47], s74 offen lds
  s_add_u32 m0, s73, 100352
  s_add_u32 s74, s76, 65536
  v_mfma_f32_32x32x16_bf16 v[128:143], v[60:63], v[120:123], v[128:143]
  buffer_load_dwordx4 v226, s[44:47], s74 offen lds
  s_add_u32 m0, s73, 101376
  s_add_u32 s74, s76, 98304
  buffer_load_dwordx4 v226, s[44:47], s74 offen lds
  s_add_u32 m0, s12, 147456
  v_mfma_f32_32x32x16_bf16 v[144:159], v[60:63], v[124:127], v[144:159]
  s_add_u32 s74, s71, 0
  buffer_load_dwordx4 v224, s[40:43], s74 offen lds
  s_add_u32 m0, s12, 148480
  s_add_u32 s74, s71, 8192
  buffer_load_dwordx4 v225, s[40:43], s74 offen lds
  s_waitcnt vmcnt(7) lgkmcnt(0)
  s_barrier
  v_mfma_f32_32x32x16_bf16 v[128:143], v[32:35], v[64:67], v[128:143]
  ds_read_b64_tr_b16 v[48:49], v227 offset:16384
  ds_read_b64_tr_b16 v[50:51], v227 offset:17408
  ds_read_b128 v[96:99], v229 offset:8192
  ds_read_b128 v[100:103], v229 offset:12288
  ds_read_b64_tr_b16 v[52:53], v227 offset:20480
  v_mfma_f32_32x32x16_bf16 v[144:159], v[32:35], v[68:71], v[144:159]
  ds_read_b64_tr_b16 v[54:55], v227 offset:21504
  ds_read_b128 v[104:107], v230 offset:8192
  ds_read_b128 v[108:111], v230 offset:12288
  ds_read_b64_tr_b16 v[56:57], v227 offset:24576
  ds_read_b64_tr_b16 v[58:59], v227 offset:25600
  v_mfma_f32_32x32x16_bf16 v[128:143], v[36:39], v[72:75], v[128:143]
  ds_read_b128 v[112:115], v231 offset:8192
  ds_read_b128 v[116:119], v231 offset:12288
  ds_read_b64_tr_b16 v[60:61], v227 offset:28672
  ds_read_b64_tr_b16 v[62:63], v227 offset:29696
  ds_read_b128 v[120:123], v232 offset:8192
  v_mfma_f32_32x32x16_bf16 v[144:159], v[36:39], v[76:79], v[144:159]
  ds_read_b128 v[124:127], v232 offset:12288
  s_add_u32 s76, s75, 7
  s_and_b32 s76, s76, 7
  s_lshl_b32 s71, s76, 7
  s_add_u32 s71, s71, s70
  v_mfma_f32_32x32x16_bf16 v[128:143], v[40:43], v[80:83], v[128:143]
  s_lshl_b32 s76, s76, 19
  s_add_u32 s76, s76, s72
  s_add_u32 m0, s73, 114688
  s_add_u32 s74, s76, 0
  buffer_load_dwordx4 v226, s[44:47], s74 offen lds
  v_mfma_f32_32x32x16_bf16 v[144:159], v[40:43], v[84:87], v[144:159]
  s_add_u32 m0, s73, 115712
  s_add_u32 s74, s76, 32768
  buffer_load_dwordx4 v226, s[44:47], s74 offen lds
  s_add_u32 m0, s73, 116736
  s_add_u32 s74, s76, 65536
  v_mfma_f32_32x32x16_bf16 v[128:143], v[44:47], v[88:91], v[128:143]
  buffer_load_dwordx4 v226, s[44:47], s74 offen lds
  s_add_u32 m0, s73, 117760
  s_add_u32 s74, s76, 98304
  buffer_load_dwordx4 v226, s[44:47], s74 offen lds
  s_add_u32 m0, s12, 155648
  v_mfma_f32_32x32x16_bf16 v[144:159], v[44:47], v[92:95], v[144:159]
  s_add_u32 s74, s71, 0
  buffer_load_dwordx4 v224, s[40:43], s74 offen lds
  s_add_u32 m0, s12, 156672
  s_add_u32 s74, s71, 8192
  buffer_load_dwordx4 v225, s[40:43], s74 offen lds
  s_waitcnt vmcnt(6) lgkmcnt(0)
  s_barrier
  v_mfma_f32_32x32x16_bf16 v[128:143], v[48:51], v[96:99], v[128:143]
  ds_read_b64_tr_b16 v[32:33], v228 offset:0
  ds_read_b64_tr_b16 v[34:35], v228 offset:1024
  v_mfma_f32_32x32x16_bf16 v[144:159], v[48:51], v[100:103], v[144:159]
  ds_read_b128 v[64:67], v229 offset:16384
  ds_read_b128 v[68:71], v229 offset:20480
  ds_read_b64_tr_b16 v[36:37], v228 offset:4096
  v_mfma_f32_32x32x16_bf16 v[128:143], v[52:55], v[104:107], v[128:143]
  ds_read_b64_tr_b16 v[38:39], v228 offset:5120
  ds_read_b128 v[72:75], v230 offset:16384
  v_mfma_f32_32x32x16_bf16 v[144:159], v[52:55], v[108:111], v[144:159]
  ds_read_b128 v[76:79], v230 offset:20480
  ds_read_b64_tr_b16 v[40:41], v228 offset:8192
  ds_read_b64_tr_b16 v[42:43], v228 offset:9216
  v_mfma_f32_32x32x16_bf16 v[128:143], v[56:59], v[112:115], v[128:143]
  ds_read_b128 v[80:83], v231 offset:16384
  ds_read_b128 v[84:87], v231 offset:20480
  v_mfma_f32_32x32x16_bf16 v[144:159], v[56:59], v[116:119], v[144:159]
  ds_read_b64_tr_b16 v[44:45], v228 offset:12288
  ds_read_b64_tr_b16 v[46:47], v228 offset:13312
  ds_read_b128 v[88:91], v232 offset:16384
  v_mfma_f32_32x32x16_bf16 v[128:143], v[60:63], v[120:123], v[128:143]
  ds_read_b128 v[92:95], v232 offset:20480
  s_add_u32 m0, s12, 0
  v_mfma_f32_32x32x16_bf16 v[144:159], v[60:63], v[124:127], v[144:159]
  s_mov_b32 s13, 0
  buffer_load_dwordx4 v10, s[32:35], s13 offen offset:0 nt lds
  buffer_load_dwordx4 v11, s[32:35], s13 offen offset:1024 nt lds
  s_waitcnt vmcnt(2) lgkmcnt(0)
  s_barrier
  v_mfma_f32_32x32x16_bf16 v[128:143], v[32:35], v[64:67], v[128:143]
  ds_read_b64_tr_b16 v[48:49], v228 offset:16384
  ds_read_b64_tr_b16 v[50:51], v228 offset:17408
  v_mfma_f32_32x32x16_bf16 v[144:159], v[32:35], v[68:71], v[144:159]
  ds_read_b128 v[96:99], v229 offset:24576
  ds_read_b128 v[100:103], v229 offset:28672
  ds_read_b64_tr_b16 v[52:53], v228 offset:20480
  v_mfma_f32_32x32x16_bf16 v[128:143], v[36:39], v[72:75], v[128:143]
  ds_read_b64_tr_b16 v[54:55], v228 offset:21504
  ds_read_b128 v[104:107], v230 offset:24576
  ds_read_b128 v[108:111], v230 offset:28672
  v_mfma_f32_32x32x16_bf16 v[144:159], v[36:39], v[76:79], v[144:159]
  ds_read_b64_tr_b16 v[56:57], v228 offset:24576
  ds_read_b64_tr_b16 v[58:59], v228 offset:25600
  ds_read_b128 v[112:115], v231 offset:24576
  v_mfma_f32_32x32x16_bf16 v[128:143], v[40:43], v[80:83], v[128:143]
  ds_read_b128 v[116:119], v231 offset:28672
  ds_read_b64_tr_b16 v[60:61], v228 offset:28672
  ds_read_b64_tr_b16 v[62:63], v228 offset:29696
  v_mfma_f32_32x32x16_bf16 v[144:159], v[40:43], v[84:87], v[144:159]
  ds_read_b128 v[120:123], v232 offset:24576
  ds_read_b128 v[124:127], v232 offset:28672
  s_lshl_b32 s66, s11, 7
  v_mfma_f32_32x32x16_bf16 v[128:143], v[44:47], v[88:91], v[128:143]
  s_add_u32 s66, s66, 34701312
  buffer_load_dwordx4 v[4:7], v5, s[52:55], s66 offen sc1
  s_add_u32 m0, s12, 8192
  v_mfma_f32_32x32x16_bf16 v[144:159], v[44:47], v[92:95], v[144:159]
  s_mov_b32 s13, 8192
  buffer_load_dwordx4 v10, s[32:35], s13 offen offset:0 nt lds
  buffer_load_dwordx4 v11, s[32:35], s13 offen offset:1024 nt lds
  s_waitcnt lgkmcnt(0)
  v_mfma_f32_32x32x16_bf16 v[128:143], v[48:51], v[96:99], v[128:143]
  v_mfma_f32_32x32x16_bf16 v[144:159], v[48:51], v[100:103], v[144:159]
  s_add_u32 m0, s12, 65536
  v_mfma_f32_32x32x16_bf16 v[128:143], v[52:55], v[104:107], v[128:143]
  v_mfma_f32_32x32x16_bf16 v[144:159], v[52:55], v[108:111], v[144:159]
  s_mov_b32 s13, 0
  v_mfma_f32_32x32x16_bf16 v[128:143], v[56:59], v[112:115], v[128:143]
  v_mfma_f32_32x32x16_bf16 v[144:159], v[56:59], v[116:119], v[144:159]
  buffer_load_dwordx4 v12, s[36:39], s13 offen offset:0 nt lds
  v_mfma_f32_32x32x16_bf16 v[128:143], v[60:63], v[120:123], v[128:143]
  v_mfma_f32_32x32x16_bf16 v[144:159], v[60:63], v[124:127], v[144:159]
  buffer_load_dwordx4 v12, s[36:39], s13 offen offset:1024 nt lds
  s_mov_b32 s14, 65536
  s_waitcnt vmcnt(4)
  s_branch L_hellochk_8
L_hello_6:
  buffer_load_dwordx4 v[4:7], v1, s[52:55], s66 offen sc1
  s_sub_u32 s14, s14, 1
  s_cbranch_scc1 L_hellox_7
  s_waitcnt vmcnt(0)
L_hellochk_8:
  v_mov_b32 v1, 0
  v_xor_b32 v4, s8, v4
  v_xor_b32 v5, s8, v5
  v_xor_b32 v6, s8, v6
  v_xor_b32 v7, s8, v7
  v_or_b32 v8, v4, v5
  v_or3_b32 v8, v8, v6, v7
  s_nop 0
  v_readfirstlane_b32 s67, v8
  s_nop 3
  s_cmp_gt_u32 s67, 7
  s_cbranch_scc1 L_hello_6
L_hellox_7:
  v_xor_b32 v4, s10, v4
  v_xor_b32 v5, s10, v5
  v_xor_b32 v6, s10, v6
  v_xor_b32 v7, s10, v7
  v_or_b32 v8, v4, v5
  v_or3_b32 v8, v8, v6, v7
  s_nop 0
  v_readfirstlane_b32 s67, v8
  s_nop 3
  s_cmp_eq_u32 s67, 0
  s_cselect_b32 s9, 1, 0
  s_mov_b32 s74, 0x3e0293ee
  v_mul_f32 v128, s74, v128
  v_mul_f32 v129, s74, v129
  v_mul_f32 v130, s74, v130
  v_mul_f32 v131, s74, v131
  v_mul_f32 v132, s74, v132
  v_mul_f32 v133, s74, v133
  v_mul_f32 v134, s74, v134
  v_mul_f32 v135, s74, v135
  v_mul_f32 v136, s74, v136
  v_mul_f32 v137, s74, v137
  v_mul_f32 v138, s74, v138
  v_mul_f32 v139, s74, v139
  v_mul_f32 v140, s74, v140
  v_mul_f32 v141, s74, v141
  v_mul_f32 v142, s74, v142
  v_mul_f32 v143, s74, v143
  v_mul_f32 v144, s74, v144
  v_mul_f32 v145, s74, v145
  v_mul_f32 v146, s74, v146
  v_mul_f32 v147, s74, v147
  v_mul_f32 v148, s74, v148
  v_mul_f32 v149, s74, v149
  v_mul_f32 v150, s74, v150
  v_mul_f32 v151, s74, v151
  v_mul_f32 v152, s74, v152
  v_mul_f32 v153, s74, v153
  v_mul_f32 v154, s74, v154
  v_mul_f32 v155, s74, v155
  v_mul_f32 v156, s74, v156
  v_mul_f32 v157, s74, v157
  v_mul_f32 v158, s74, v158
  v_mul_f32 v159, s74, v159
  v_cvt_pk_bf16_f32 v32, v128, v129
  v_cvt_pk_bf16_f32 v33, v130, v131
  v_cvt_pk_bf16_f32 v34, v132, v133
  v_cvt_pk_bf16_f32 v35, v134, v135
  v_cvt_pk_bf16_f32 v36, v136, v137
  v_cvt_pk_bf16_f32 v37, v138, v139
  v_cvt_pk_bf16_f32 v38, v140, v141
  v_cvt_pk_bf16_f32 v39, v142, v143
  v_cvt_pk_bf16_f32 v40, v144, v145
  v_cvt_pk_bf16_f32 v41, v146, v147
  v_cvt_pk_bf16_f32 v42, v148, v149
  v_cvt_pk_bf16_f32 v43, v150, v151
  v_cvt_pk_bf16_f32 v44, v152, v153
  v_cvt_pk_bf16_f32 v45, v154, v155
  v_cvt_pk_bf16_f32 v46, v156, v157
  v_cvt_pk_bf16_f32 v47, v158, v159
  s_cmp_eq_u32 s9, 0
  s_cbranch_scc1 L_sg_9
  s_add_u32 s66, s65, 0
  buffer_store_dwordx4 v[32:35], v14, s[52:55], s66 offen
  s_add_u32 s66, s65, 1024
  buffer_store_dwordx4 v[36:39], v14, s[52:55], s66 offen
  s_add_u32 s66, s65, 8192
  buffer_store_dwordx4 v[40:43], v14, s[52:55], s66 offen
  s_add_u32 s66, s65, 9216
  buffer_store_dwordx4 v[44:47], v14, s[52:55], s66 offen
  s_branch L_se_10
L_sg_9:
  s_add_u32 s66, s65, 0
  buffer_store_dwordx4 v[32:35], v14, s[52:55], s66 offen sc0 sc1
  s_add_u32 s66, s65, 1024
  buffer_store_dwordx4 v[36:39], v14, s[52:55], s66 offen sc0 sc1
  s_add_u32 s66, s65, 8192
  buffer_store_dwordx4 v[40:43], v14, s[52:55], s66 offen sc0 sc1
  s_add_u32 s66, s65, 9216
  buffer_store_dwordx4 v[44:47], v14, s[52:55], s66 offen sc0 sc1
L_se_10:
  s_add_u32 m0, s12, 16384
  s_mov_b32 s13, 16384
  buffer_load_dwordx4 v10, s[32:35], s13 offen offset:0 nt lds
  buffer_load_dwordx4 v11, s[32:35], s13 offen offset:1024 nt lds
  v_and_b32 v4, 31, v0
  v_lshrrev_b32 v5, 5, v0
  v_and_b32 v6, 15, v0
  v_add_u32 v7, 0, v5
  v_xor_b32 v7, v7, v6
  v_lshlrev_b32 v7, 4, v7
  v_lshl_add_u32 v16, v4, 8, v7
  v_add_u32 v7, 2, v5
  v_xor_b32 v7, v7, v6
  v_lshlrev_b32 v7, 4, v7
  v_lshl_add_u32 v17, v4, 8, v7
  v_add_u32 v7, 4, v5
  v_xor_b32 v7, v7, v6
  v_lshlrev_b32 v7, 4, v7
  v_lshl_add_u32 v18, v4, 8, v7
  v_add_u32 v7, 6, v5
  v_xor_b32 v7, v7, v6
  v_lshlrev_b32 v7, 4, v7
  v_lshl_add_u32 v19, v4, 8, v7
  v_add_u32 v7, 8, v5
  v_xor_b32 v7, v7, v6
  v_lshlrev_b32 v7, 4, v7
  v_lshl_add_u32 v20, v4, 8, v7
  v_add_u32 v7, 10, v5
  v_xor_b32 v7, v7, v6
  v_lshlrev_b32 v7, 4, v7
  v_lshl_add_u32 v21, v4, 8, v7
  v_add_u32 v7, 12, v5
  v_xor_b32 v7, v7, v6
  v_lshlrev_b32 v7, 4, v7
  v_lshl_add_u32 v22, v4, 8, v7
  v_add_u32 v7, 14, v5
  v_xor_b32 v7, v7, v6
  v_lshlrev_b32 v7, 4, v7
  v_lshl_add_u32 v23, v4, 8, v7
  s_lshl_b32 s66, s11, 7
  s_lshl_b32 s67, s6, 4
  s_add_u32 s67, s67, s66
  s_lshl_b32 s68, s3, 2
  s_add_u32 s67, s67, s68
  s_add_u32 s67, s67, 34603008
  s_waitcnt vmcnt(2)
  v_mov_b32 v4, s8
  v_mov_b32 v5, 0
  s_mov_b64 exec, 1
  s_cmp_eq_u32 s9, 0
  s_cbranch_scc1 L_fg_11
  buffer_store_dword v4, v5, s[52:55], s67 offen
  s_branch L_fe_12
L_fg_11:
  buffer_store_dword v4, v5, s[52:55], s67 offen sc0 sc1
L_fe_12:
  s_mov_b64 exec, -1
  v_bfe_u32 v4, v0, 4, 1
  v_and_b32 v5, 3, v0
  v_lshrrev_b32 v6, 1, v5
  v_and_b32 v5, 1, v5
  v_lshl_add_u32 v6, v4, 1, v6
  v_add_u32 v6, 0, v6
  v_bfe_u32 v4, v0, 2, 2
  v_lshlrev_b32 v7, 2, v4
  v_xor_b32 v6, v6, v7
  v_lshlrev_b32 v6, 4, v6
  v_lshl_add_u32 v6, v5, 3, v6
  v_lshrrev_b32 v7, 5, v0
  v_lshl_add_u32 v7, v7, 2, v4
  v_lshl_add_u32 v24, v7, 8, v6
  v_add_u32 v24, 0x10000, v24
  v_bfe_u32 v4, v0, 4, 1
  v_and_b32 v5, 3, v0
  v_lshrrev_b32 v6, 1, v5
  v_and_b32 v5, 1, v5
  v_lshl_add_u32 v6, v4, 1, v6
  v_add_u32 v6, 4, v6
  v_bfe_u32 v4, v0, 2, 2
  v_lshlrev_b32 v7, 2, v4
  v_xor_b32 v6, v6, v7
  v_lshlrev_b32 v6, 4, v6
  v_lshl_add_u32 v6, v5, 3, v6
  v_lshrrev_b32 v7, 5, v0
  v_lshl_add_u32 v7, v7, 2, v4
  v_lshl_add_u32 v25, v7, 8, v6
  v_add_u32 v25, 0x10000, v25
  v_bfe_u32 v4, v0, 4, 1
  v_and_b32 v5, 3, v0
  v_lshrrev_b32 v6, 1, v5
  v_and_b32 v5, 1, v5
  v_lshl_add_u32 v6, v4, 1, v6
  v_add_u32 v6, 8, v6
  v_bfe_u32 v4, v0, 2, 2
  v_lshlrev_b32 v7, 2, v4
  v_xor_b32 v6, v6, v7
  v_lshlrev_b32 v6, 4, v6
  v_lshl_add_u32 v6, v5, 3, v6
  v_lshrrev_b32 v7, 5, v0
  v_lshl_add_u32 v7, v7, 2, v4
  v_lshl_add_u32 v26, v7, 8, v6
  v_add_u32 v26, 0x10000, v26
  v_bfe_u32 v4, v0, 4, 1
  v_and_b32 v5, 3, v0
  v_lshrrev_b32 v6, 1, v5
  v_and_b32 v5, 1, v5
  v_lshl_add_u32 v6, v4, 1, v6
  v_add_u32 v6, 12, v6
  v_bfe_u32 v4, v0, 2, 2
  v_lshlrev_b32 v7, 2, v4
  v_xor_b32 v6, v6, v7
  v_lshlrev_b32 v6, 4, v6
  v_lshl_add_u32 v6, v5, 3, v6
  v_lshrrev_b32 v7, 5, v0
  v_lshl_add_u32 v7, v7, 2, v4
  v_lshl_add_u32 v27, v7, 8, v6
  v_add_u32 v27, 0x10000, v27
  s_lshl_b32 s67, s3, 4
  s_add_u32 s67, s67, s66
  s_add_u32 s67, s67, 34603008
  s_lshl_b32 s68, s4, 19
  s_lshl_b32 s69, s6, 8
  s_add_u32 s68, s68, s69
  s_add_u32 s48, s24, s68
  s_addc_u32 s49, s25, 0
  s_mov_b32 s50, 0x400000
  s_mov_b32 s51, 0x20000
  s_sub_u32 s50, s50, s68
  s_add_u32 s70, s6, 0
  s_and_b32 s70, s70, 3
  s_lshl_b32 s70, s70, 17
  s_add_u32 s71, s6, 1
  s_and_b32 s71, s71, 3
  s_lshl_b32 s71, s71, 17
  s_add_u32 s72, s6, 2
  s_and_b32 s72, s72, 3
  s_lshl_b32 s72, s72, 17
  s_add_u32 s73, s6, 3
  s_and_b32 s73, s73, 3
  s_lshl_b32 s73, s73, 17
  s_lshl_b32 s77, s11, 2
  s_add_u32 s77, s77, s3
  s_lshl_b32 s77, s77, 2
  s_add_u32 s77, s77, s6
  s_lshl_b32 s78, s77, 9
  s_add_u32 s78, s78, 20971520
  s_lshl_b32 s77, s77, 14
  s_add_u32 s77, s77, 4194304
  s_xor_b32 s76, s9, 1
  s_cmp_eq_u32 s3, s6
  s_cselect_b32 s76, 2, s76
  v_and_b32 v235, 3, v0
  v_lshlrev_b32 v235, 7, v235
  v_and_b32 v236, 15, v0
  s_cselect_b32 s13, 0, 128
  v_mul_u32_u24 v236, s13, v236
  v_bfe_u32 v4, v0, 3, 2
  v_and_b32 v5, 7, v0
  v_lshlrev_b32 v5, 7, v5
  v_lshl_add_u32 v234, v4, 10, v5
  s_lshl_b32 s75, s5, 5
  s_lshl_b32 s13, s4, 2
  s_add_u32 s75, s75, s13
  s_add_u32 s75, s75, s6
  s_lshl_b32 s75, s75, 14
  s_add_u32 s75, s75, s12
  s_add_u32 s75, s75, 0
  s_mov_b32 s14, 65536
L_poll_13:
  buffer_load_dword v4, v15, s[52:55], s67 offen sc1
  s_sub_u32 s14, s14, 1
  s_cbranch_scc1 L_pollx_14
  s_waitcnt vmcnt(0)
  v_cmp_ne_u32 vcc, s8, v4
  s_nop 4
  s_and_b32 s79, vcc_lo, 0xf
  s_cbranch_scc1 L_poll_13
L_pollx_14:
  s_add_u32 s65, s64, s3
  s_lshl_b32 s65, s65, 14
  s_add_u32 s66, s65, 0
  buffer_load_dwordx4 a[128:131], v14, s[52:55], s66 offen offset:0 sc1
  buffer_load_dwordx4 a[132:135], v14, s[52:55], s66 offen offset:1024 sc1
  buffer_load_dwordx4 a[136:139], v14, s[52:55], s66 offen offset:2048 sc1
  buffer_load_dwordx4 a[140:143], v14, s[52:55], s66 offen offset:3072 sc1
  s_add_u32 s66, s65, 4096
  buffer_load_dwordx4 a[144:147], v14, s[52:55], s66 offen offset:0 sc1
  buffer_load_dwordx4 a[148:151], v14, s[52:55], s66 offen offset:1024 sc1
  buffer_load_dwordx4 a[152:155], v14, s[52:55], s66 offen offset:2048 sc1
  buffer_load_dwordx4 a[156:159], v14, s[52:55], s66 offen offset:3072 sc1
  s_add_u32 s66, s65, 8192
  buffer_load_dwordx4 a[160:163], v14, s[52:55], s66 offen offset:0 sc1
  buffer_load_dwordx4 a[164:167], v14, s[52:55], s66 offen offset:1024 sc1
  buffer_load_dwordx4 a[168:171], v14, s[52:55], s66 offen offset:2048 sc1
  buffer_load_dwordx4 a[172:175], v14, s[52:55], s66 offen offset:3072 sc1
  s_add_u32 s66, s65, 12288
  buffer_load_dwordx4 a[176:179], v14, s[52:55], s66 offen offset:0 sc1
  buffer_load_dwordx4 a[180:183], v14, s[52:55], s66 offen offset:1024 sc1
  buffer_load_dwordx4 a[184:187], v14, s[52:55], s66 offen offset:2048 sc1
  buffer_load_dwordx4 a[188:191], v14, s[52:55], s66 offen offset:3072 sc1
  s_barrier
  ds_read_b128 a[192:195], v16 offset:0
  ds_read_b128 a[196:199], v17 offset:0
  ds_read_b128 a[200:203], v18 offset:0
  ds_read_b128 a[204:207], v19 offset:0
  ds_read_b128 a[208:211], v20 offset:0
  ds_read_b128 a[212:215], v21 offset:0
  ds_read_b128 a[216:219], v22 offset:0
  ds_read_b128 a[220:223], v23 offset:0
  s_add_u32 m0, s12, 73728
  s_mov_b32 s13, 8192
  buffer_load_dwordx4 v12, s[36:39], s13 offen offset:0 nt lds
  buffer_load_dwordx4 v12, s[36:39], s13 offen offset:1024 nt lds
  s_add_u32 m0, s12, 24576
  s_mov_b32 s13, 24576
  buffer_load_dwordx4 v10, s[32:35], s13 offen offset:0 nt lds
  buffer_load_dwordx4 v11, s[32:35], s13 offen offset:1024 nt lds
  s_add_u32 m0, s12, 81920
  s_mov_b32 s13, 16384
  buffer_load_dwordx4 v12, s[36:39], s13 offen offset:0 nt lds
  buffer_load_dwordx4 v12, s[36:39], s13 offen offset:1024 nt lds
  s_add_u32 m0, s12, 90112
  s_mov_b32 s13, 24576
  buffer_load_dwordx4 v12, s[36:39], s13 offen offset:0 nt lds
  buffer_load_dwordx4 v12, s[36:39], s13 offen offset:1024 nt lds
  v_and_b32 v4, 15, v0
  v_bfe_u32 v5, v0, 4, 1
  v_cmp_eq_u32 vcc, v4, v5
  v_mov_b32 v6, 0x3f803f80
  s_nop 1
  v_cndmask_b32 v240, 0, v6, vcc
  v_mov_b32 v241, v240
  v_mov_b32 v242, v240
  v_mov_b32 v243, v240
  s_waitcnt vmcnt(8) lgkmcnt(0)
  v_mfma_f32_32x32x16_bf16 v[32:47], a[192:195], a[128:131], 0
  v_mfma_f32_32x32x16_bf16 v[32:47], a[196:199], a[132:135], v[32:47]
  v_mfma_f32_32x32x16_bf16 v[32:47], a[200:203], a[136:139], v[32:47]
  v_mfma_f32_32x32x16_bf16 v[32:47], a[204:207], a[140:143], v[32:47]
  v_mfma_f32_32x32x16_bf16 v[32:47], a[208:211], a[144:147], v[32:47]
  v_mfma_f32_32x32x16_bf16 v[32:47], a[212:215], a[148:151], v[32:47]
  v_mfma_f32_32x32x16_bf16 v[32:47], a[216:219], a[152:155], v[32:47]
  v_mfma_f32_32x32x16_bf16 v[32:47], a[220:223], a[156:159], v[32:47]
  v_mfma_f32_32x32x16_bf16 v[48:63], a[192:195], a[160:163], 0
  v_mfma_f32_32x32x16_bf16 v[48:63], a[196:199], a[164:167], v[48:63]
  v_mfma_f32_32x32x16_bf16 v[48:63], a[200:203], a[168:171], v[48:63]
  s_nop 8
  v_max3_f32 v30, v32, v33, v34
  v_max3_f32 v30, v30, v35, v36
  v_max3_f32 v30, v30, v37, v38
  v_max3_f32 v30, v30, v39, v40
  v_max3_f32 v30, v30, v41, v42
  v_max3_f32 v30, v30, v43, v44
  v_max3_f32 v30, v30, v45, v46
  v_mfma_f32_32x32x16_bf16 v[48:63], a[204:207], a[172:175], v[48:63]
  v_max_f32 v30, v30, v47
  v_mov_b32 v4, v30
  s_nop 1
  v_permlane32_swap_b32 v30, v4
  s_nop 1
  v_max_f32 v30, v30, v4
  v_sub_f32 v128, 0, v30
  v_sub_f32 v129, 0, v30
  v_mfma_f32_32x32x16_bf16 v[48:63], a[208:211], a[176:179], v[48:63]
  v_sub_f32 v130, 0, v30
  v_sub_f32 v131, 0, v30
  v_sub_f32 v132, 0, v30
  v_sub_f32 v133, 0, v30
  v_sub_f32 v134, 0, v30
  v_sub_f32 v135, 0, v30
  v_sub_f32 v136, 0, v30
  v_mfma_f32_32x32x16_bf16 v[48:63], a[212:215], a[180:183], v[48:63]
  v_sub_f32 v137, 0, v30
  v_sub_f32 v138, 0, v30
  v_sub_f32 v139, 0, v30
  v_sub_f32 v140, 0, v30
  v_sub_f32 v141, 0, v30
  v_sub_f32 v142, 0, v30
  v_sub_f32 v143, 0, v30
  v_sub_f32 v32, v32, v30
  v_mfma_f32_32x32x16_bf16 v[48:63], a[216:219], a[184:187], v[48:63]
  v_sub_f32 v33, v33, v30
  v_sub_f32 v34, v34, v30
  v_sub_f32 v35, v35, v30
  v_sub_f32 v36, v36, v30
  v_sub_f32 v37, v37, v30
  v_sub_f32 v38, v38, v30
  v_sub_f32 v39, v39, v30
  v_mfma_f32_32x32x16_bf16 v[48:63], a[220:223], a[188:191], v[48:63]
  v_sub_f32 v40, v40, v30
  v_sub_f32 v41, v41, v30
  v_sub_f32 v42, v42, v30
  v_sub_f32 v43, v43, v30
  v_sub_f32 v44, v44, v30
  v_sub_f32 v45, v45, v30
  v_sub_f32 v46, v46, v30
  v_sub_f32 v47, v47, v30
  ds_read_b128 a[192:195], v16 offset:8192
  ds_read_b128 a[196:199], v17 offset:8192
  ds_read_b128 a[200:203], v18 offset:8192
  ds_read_b128 a[204:207], v19 offset:8192
  ds_read_b128 a[208:211], v20 offset:8192
  ds_read_b128 a[212:215], v21 offset:8192
  ds_read_b128 a[216:219], v22 offset:8192
  ds_read_b128 a[220:223], v23 offset:8192
  v_mov_b32 v28, 0
  v_mov_b32 v29, 0
  s_waitcnt lgkmcnt(0)
  v_mfma_f32_32x32x16_bf16 v[64:79], a[192:195], a[128:131], v[128:143]
  s_waitcnt vmcnt(63) lgkmcnt(0)
  s_barrier
  v_exp_f32 v32, v32
  v_exp_f32 v33, v33
  v_exp_f32 v34, v34
  v_cvt_pk_bf16_f32 v96, v32, v33
  v_exp_f32 v35, v35
  v_exp_f32 v36, v36
  v_cvt_pk_bf16_f32 v97, v34, v35
  v_exp_f32 v37, v37
  v_mfma_f32_32x32x16_bf16 v[64:79], a[196:199], a[132:135], v[64:79]
  v_exp_f32 v38, v38
  v_cvt_pk_bf16_f32 v98, v36, v37
  v_exp_f32 v39, v39
  v_exp_f32 v40, v40
  v_cvt_pk_bf16_f32 v99, v38, v39
  v_exp_f32 v41, v41
  v_exp_f32 v42, v42
  v_cvt_pk_bf16_f32 v100, v40, v41
  v_exp_f32 v43, v43
  ds_read_b64_tr_b16 a[224:225], v24 offset:0
  v_mfma_f32_32x32x16_bf16 v[64:79], a[200:203], a[136:139], v[64:79]
  v_exp_f32 v44, v44
  v_cvt_pk_bf16_f32 v101, v42, v43
  v_exp_f32 v45, v45
  v_exp_f32 v46, v46
  v_cvt_pk_bf16_f32 v102, v44, v45
  v_exp_f32 v47, v47
  s_nop 0
  v_cvt_pk_bf16_f32 v103, v46, v47
  v_max3_f32 v31, v48, v49, v50
  ds_read_b64_tr_b16 a[226:227], v24 offset:2048
  v_mfma_f32_32x32x16_bf16 v[64:79], a[204:207], a[140:143], v[64:79]
  v_max3_f32 v31, v31, v51, v52
  v_max3_f32 v31, v31, v53, v54
  v_max3_f32 v31, v31, v55, v56
  v_max3_f32 v31, v31, v57, v58
  v_max3_f32 v31, v31, v59, v60
  v_max3_f32 v31, v31, v61, v62
  v_max_f32 v31, v31, v63
  v_mov_b32 v4, v31
  s_nop 1
  ds_read_b64_tr_b16 a[232:233], v25 offset:0
  ds_read_b64_tr_b16 a[234:235], v25 offset:2048
  v_mfma_f32_32x32x16_bf16 v[64:79], a[208:211], a[144:147], v[64:79]
  v_permlane32_swap_b32 v31, v4
  s_nop 1
  v_max_f32 v31, v31, v4
  v_sub_f32 v144, 0, v31
  v_sub_f32 v145, 0, v31
  v_sub_f32 v146, 0, v31
  v_sub_f32 v147, 0, v31
  v_sub_f32 v148, 0, v31
  ds_read_b64_tr_b16 a[240:241], v26 offset:0
  v_mfma_f32_32x32x16_bf16 v[64:79], a[212:215], a[148:151], v[64:79]
  v_sub_f32 v149, 0, v31
  v_sub_f32 v150, 0, v31
  v_sub_f32 v151, 0, v31
  v_sub_f32 v152, 0, v31
  v_sub_f32 v153, 0, v31
  v_sub_f32 v154, 0, v31
  v_sub_f32 v155, 0, v31
  v_sub_f32 v156, 0, v31
  v_sub_f32 v157, 0, v31
  ds_read_b64_tr_b16 a[242:243], v26 offset:2048
  ds_read_b64_tr_b16 a[248:249], v27 offset:0
  v_mfma_f32_32x32x16_bf16 v[64:79], a[216:219], a[152:155], v[64:79]
  v_sub_f32 v158, 0, v31
  v_sub_f32 v159, 0, v31
  v_sub_f32 v48, v48, v31
  v_sub_f32 v49, v49, v31
  v_sub_f32 v50, v50, v31
  v_sub_f32 v51, v51, v31
  v_sub_f32 v52, v52, v31
  v_sub_f32 v53, v53, v31
  v_sub_f32 v54, v54, v31
  ds_read_b64_tr_b16 a[250:251], v27 offset:2048
  v_mfma_f32_32x32x16_bf16 v[64:79], a[220:223], a[156:159], v[64:79]
  v_sub_f32 v55, v55, v31
  v_sub_f32 v56, v56, v31
  v_sub_f32 v57, v57, v31
  v_sub_f32 v58, v58, v31
  v_sub_f32 v59, v59, v31
  v_sub_f32 v60, v60, v31
  v_sub_f32 v61, v61, v31
  v_sub_f32 v62, v62, v31
  v_sub_f32 v63, v63, v31
  s_nop 1
  ds_read_b64_tr_b16 a[228:229], v24 offset:4096
  ds_read_b64_tr_b16 a[230:231], v24 offset:6144
  v_mfma_f32_32x32x16_bf16 v[80:95], a[192:195], a[160:163], v[144:159]
  v_exp_f32 v48, v48
  v_exp_f32 v49, v49
  ds_read_b64_tr_b16 a[236:237], v25 offset:4096
  v_mfma_f32_32x32x16_bf16 v[80:95], a[196:199], a[164:167], v[80:95]
  v_exp_f32 v50, v50
  v_cvt_pk_bf16_f32 v104, v48, v49
  v_exp_f32 v51, v51
  ds_read_b64_tr_b16 a[238:239], v25 offset:6144
  ds_read_b64_tr_b16 a[244:245], v26 offset:4096
  v_mfma_f32_32x32x16_bf16 v[80:95], a[200:203], a[168:171], v[80:95]
  v_exp_f32 v52, v52
  v_cvt_pk_bf16_f32 v105, v50, v51
  v_exp_f32 v53, v53
  ds_read_b64_tr_b16 a[246:247], v26 offset:6144
  v_mfma_f32_32x32x16_bf16 v[80:95], a[204:207], a[172:175], v[80:95]
  v_exp_f32 v54, v54
  v_cvt_pk_bf16_f32 v106, v52, v53
  v_exp_f32 v55, v55
  ds_read_b64_tr_b16 a[252:253], v27 offset:4096
  ds_read_b64_tr_b16 a[254:255], v27 offset:6144
  v_mfma_f32_32x32x16_bf16 v[80:95], a[208:211], a[176:179], v[80:95]
  v_exp_f32 v56, v56
  v_cvt_pk_bf16_f32 v107, v54, v55
  v_exp_f32 v57, v57
  v_mfma_f32_32x32x16_bf16 v[80:95], a[212:215], a[180:183], v[80:95]
  v_exp_f32 v58, v58
  v_cvt_pk_bf16_f32 v108, v56, v57
  v_exp_f32 v59, v59
  v_mfma_f32_32x32x16_bf16 v[80:95], a[216:219], a[184:187], v[80:95]
  v_exp_f32 v60, v60
  v_cvt_pk_bf16_f32 v109, v58, v59
  v_exp_f32 v61, v61
  v_mfma_f32_32x32x16_bf16 v[80:95], a[220:223], a[188:191], v[80:95]
  v_exp_f32 v62, v62
  v_cvt_pk_bf16_f32 v110, v60, v61
  v_exp_f32 v63, v63
  s_nop 0
  v_cvt_pk_bf16_f32 v111, v62, v63
  s_waitcnt lgkmcnt(0)
  v_mfma_f32_32x32x16_bf16 v[160:175], a[224:227], v[96:99], 0
  v_exp_f32 v64, v64
  ds_read_b128 a[192:195], v16 offset:16384
  v_mfma_f32_32x32x16_bf16 v[176:191], a[232:235], v[96:99], 0
  v_exp_f32 v65, v65
  ds_read_b128 a[196:199], v17 offset:16384
  v_mfma_f32_32x32x16_bf16 v[192:207], a[240:243], v[96:99], 0
  v_exp_f32 v66, v66
  v_cvt_pk_bf16_f32 v112, v64, v65
  ds_read_b128 a[200:203], v18 offset:16384
  v_mfma_f32_32x32x16_bf16 v[208:223], a[248:251], v[96:99], 0
  v_mfma_f32_16x16x32_bf16 v[244:247], v[240:243], v[96:99], 0
  v_exp_f32 v67, v67
  ds_read_b128 a[204:207], v19 offset:16384
  v_mfma_f32_32x32x16_bf16 v[160:175], a[228:231], v[100:103], v[160:175]
  v_exp_f32 v68, v68
  v_cvt_pk_bf16_f32 v113, v66, v67
  ds_read_b128 a[208:211], v20 offset:16384
  v_mfma_f32_32x32x16_bf16 v[176:191], a[236:239], v[100:103], v[176:191]
  v_exp_f32 v69, v69
  ds_read_b128 a[212:215], v21 offset:16384
  v_mfma_f32_32x32x16_bf16 v[192:207], a[244:247], v[100:103], v[192:207]
  v_exp_f32 v70, v70
  v_cvt_pk_bf16_f32 v114, v68, v69
  ds_read_b128 a[216:219], v22 offset:16384
  v_mfma_f32_32x32x16_bf16 v[208:223], a[252:255], v[100:103], v[208:223]
  v_mfma_f32_16x16x32_bf16 v[244:247], v[240:243], v[100:103], v[244:247]
  v_exp_f32 v71, v71
  ds_read_b128 a[220:223], v23 offset:16384
  v_mfma_f32_32x32x16_bf16 a[0:15], a[224:227], v[104:107], 0
  v_exp_f32 v72, v72
  v_cvt_pk_bf16_f32 v115, v70, v71
  s_add_u32 m0, s12, 32768
  s_mov_b32 s13, 32768
  v_mfma_f32_32x32x16_bf16 a[16:31], a[232:235], v[104:107], 0
  v_exp_f32 v73, v73
  buffer_load_dwordx4 v10, s[32:35], s13 offen offset:0 nt lds
  buffer_load_dwordx4 v11, s[32:35], s13 offen offset:1024 nt lds
  v_mfma_f32_32x32x16_bf16 a[32:47], a[240:243], v[104:107], 0
  v_exp_f32 v74, v74
  v_cvt_pk_bf16_f32 v116, v72, v73
  s_add_u32 m0, s12, 40960
  s_mov_b32 s13, 40960
  v_mfma_f32_32x32x16_bf16 a[48:63], a[248:251], v[104:107], 0
  v_mfma_f32_16x16x32_bf16 v[248:251], v[240:243], v[104:107], 0
  v_exp_f32 v75, v75
  buffer_load_dwordx4 v10, s[32:35], s13 offen offset:0 nt lds
  buffer_load_dwordx4 v11, s[32:35], s13 offen offset:1024 nt lds
  s_add_u32 m0, s12, 49152
  v_mfma_f32_32x32x16_bf16 a[0:15], a[228:231], v[108:111], a[0:15]
  v_exp_f32 v76, v76
  v_cvt_pk_bf16_f32 v117, v74, v75
  s_mov_b32 s13, 49152
  buffer_load_dwordx4 v10, s[32:35], s13 offen offset:0 nt lds
  v_mfma_f32_32x32x16_bf16 a[16:31], a[236:239], v[108:111], a[16:31]
  v_exp_f32 v77, v77
  buffer_load_dwordx4 v11, s[32:35], s13 offen offset:1024 nt lds
  s_add_u32 m0, s12, 131072
  v_mfma_f32_32x32x16_bf16 a[32:47], a[244:247], v[108:111], a[32:47]
  v_exp_f32 v78, v78
  v_cvt_pk_bf16_f32 v118, v76, v77
  s_add_u32 s13, s70, 0
  buffer_load_dwordx4 v13, s[48:51], s13 offen lds
  v_mfma_f32_32x32x16_bf16 a[48:63], a[252:255], v[108:111], a[48:63]
  v_mfma_f32_16x16x32_bf16 v[248:251], v[240:243], v[108:111], v[248:251]
  v_exp_f32 v79, v79
  s_add_u32 m0, s12, 132096
  s_add_u32 s13, s70, 4096
  buffer_load_dwordx4 v13, s[48:51], s13 offen lds
  s_nop 0
  v_cvt_pk_bf16_f32 v119, v78, v79
  s_waitcnt lgkmcnt(0)
  v_mfma_f32_32x32x16_bf16 v[32:47], a[192:195], a[128:131], v[128:143]
  s_waitcnt vmcnt(12) lgkmcnt(0)
  s_barrier
  v_exp_f32 v80, v80
  v_mfma_f32_32x32x16_bf16 v[32:47], a[196:199], a[132:135], v[32:47]
  v_exp_f32 v81, v81
  ds_read_b64_tr_b16 a[224:225], v24 offset:8192
  v_mfma_f32_32x32x16_bf16 v[32:47], a[200:203], a[136:139], v[32:47]
  v_exp_f32 v82, v82
  v_cvt_pk_bf16_f32 v120, v80, v81
  ds_read_b64_tr_b16 a[226:227], v24 offset:10240
  v_mfma_f32_32x32x16_bf16 v[32:47], a[204:207], a[140:143], v[32:47]
  v_exp_f32 v83, v83
  ds_read_b64_tr_b16 a[232:233], v25 offset:8192
  ds_read_b64_tr_b16 a[234:235], v25 offset:10240
  v_mfma_f32_32x32x16_bf16 v[32:47], a[208:211], a[144:147], v[32:47]
  v_exp_f32 v84, v84
  v_cvt_pk_bf16_f32 v121, v82, v83
  ds_read_b64_tr_b16 a[240:241], v26 offset:8192
  v_mfma_f32_32x32x16_bf16 v[32:47], a[212:215], a[148:151], v[32:47]
  v_exp_f32 v85, v85
  ds_read_b64_tr_b16 a[242:243], v26 offset:10240
  ds_read_b64_tr_b16 a[248:249], v27 offset:8192
  v_mfma_f32_32x32x16_bf16 v[32:47], a[216:219], a[152:155], v[32:47]
  v_exp_f32 v86, v86
  v_cvt_pk_bf16_f32 v122, v84, v85
  ds_read_b64_tr_b16 a[250:251], v27 offset:10240
  v_mfma_f32_32x32x16_bf16 v[32:47], a[220:223], a[156:159], v[32:47]
  v_exp_f32 v87, v87
  ds_read_b64_tr_b16 a[228:229], v24 offset:12288
  ds_read_b64_tr_b16 a[230:231], v24 offset:14336
  v_mfma_f32_32x32x16_bf16 v[48:63], a[192:195], a[160:163], v[144:159]
  v_exp_f32 v88, v88
  v_cvt_pk_bf16_f32 v123, v86, v87
  ds_read_b64_tr_b16 a[236:237], v25 offset:12288
  v_mfma_f32_32x32x16_bf16 v[48:63], a[196:199], a[164:167], v[48:63]
  v_exp_f32 v89, v89
  ds_read_b64_tr_b16 a[238:239], v25 offset:14336
  ds_read_b64_tr_b16 a[244:245], v26 offset:12288
  v_mfma_f32_32x32x16_bf16 v[48:63], a[200:203], a[168:171], v[48:63]
  v_exp_f32 v90, v90
  v_cvt_pk_bf16_f32 v124, v88, v89
  ds_read_b64_tr_b16 a[246:247], v26 offset:14336
  v_mfma_f32_32x32x16_bf16 v[48:63], a[204:207], a[172:175], v[48:63]
  v_exp_f32 v91, v91
  ds_read_b64_tr_b16 a[252:253], v27 offset:12288
  ds_read_b64_tr_b16 a[254:255], v27 offset:14336
  v_mfma_f32_32x32x16_bf16 v[48:63], a[208:211], a[176:179], v[48:63]
  v_exp_f32 v92, v92
  v_cvt_pk_bf16_f32 v125, v90, v91
  v_mfma_f32_32x32x16_bf16 v[48:63], a[212:215], a[180:183], v[48:63]
  v_exp_f32 v93, v93
  v_mfma_f32_32x32x16_bf16 v[48:63], a[216:219], a[184:187], v[48:63]
  v_exp_f32 v94, v94
  v_cvt_pk_bf16_f32 v126, v92, v93
  v_mfma_f32_32x32x16_bf16 v[48:63], a[220:223], a[188:191], v[48:63]
  v_exp_f32 v95, v95
  s_nop 0
  v_cvt_pk_bf16_f32 v127, v94, v95
  s_waitcnt lgkmcnt(0)
  v_mfma_f32_32x32x16_bf16 v[160:175], a[224:227], v[112:115], v[160:175]
  v_exp_f32 v32, v32
  ds_read_b128 a[192:195], v16 offset:24576
  v_mfma_f32_32x32x16_bf16 v[176:191], a[232:235], v[112:115], v[176:191]
  v_exp_f32 v33, v33
  ds_read_b128 a[196:199], v17 offset:24576
  v_mfma_f32_32x32x16_bf16 v[192:207], a[240:243], v[112:115], v[192:207]
  v_exp_f32 v34, v34
  v_cvt_pk_bf16_f32 v96, v32, v33
  ds_read_b128 a[200:203], v18 offset:24576
  v_mfma_f32_32x32x16_bf16 v[208:223], a[248:251], v[112:115], v[208:223]
  v_mfma_f32_16x16x32_bf16 v[244:247], v[240:243], v[112:115], v[244:247]
  v_exp_f32 v35, v35
  ds_read_b128 a[204:207], v19 offset:24576
  v_mfma_f32_32x32x16_bf16 v[160:175], a[228:231], v[116:119], v[160:175]
  v_exp_f32 v36, v36
  v_cvt_pk_bf16_f32 v97, v34, v35
  ds_read_b128 a[208:211], v20 offset:24576
  v_mfma_f32_32x32x16_bf16 v[176:191], a[236:239], v[116:119], v[176:191]
  v_exp_f32 v37, v37
  ds_read_b128 a[212:215], v21 offset:24576
  v_mfma_f32_32x32x16_bf16 v[192:207], a[244:247], v[116:119], v[192:207]
  v_exp_f32 v38, v38
  v_cvt_pk_bf16_f32 v98, v36, v37
  ds_read_b128 a[216:219], v22 offset:24576
  v_mfma_f32_32x32x16_bf16 v[208:223], a[252:255], v[116:119], v[208:223]
  v_mfma_f32_16x16x32_bf16 v[244:247], v[240:243], v[116:119], v[244:247]
  v_exp_f32 v39, v39
  ds_read_b128 a[220:223], v23 offset:24576
  v_mfma_f32_32x32x16_bf16 a[0:15], a[224:227], v[120:123], a[0:15]
  v_exp_f32 v40, v40
  v_cvt_pk_bf16_f32 v99, v38, v39
  s_add_u32 m0, s12, 98304
  s_mov_b32 s13, 32768
  v_mfma_f32_32x32x16_bf16 a[16:31], a[232:235], v[120:123], a[16:31]
  v_exp_f32 v41, v41
  buffer_load_dwordx4 v12, s[36:39], s13 offen offset:0 nt lds
  buffer_load_dwordx4 v12, s[36:39], s13 offen offset:1024 nt lds
  v_mfma_f32_32x32x16_bf16 a[32:47], a[240:243], v[120:123], a[32:47]
  v_exp_f32 v42, v42
  v_cvt_pk_bf16_f32 v100, v40, v41
  s_add_u32 m0, s12, 57344
  s_mov_b32 s13, 57344
  v_mfma_f32_32x32x16_bf16 a[48:63], a[248:251], v[120:123], a[48:63]
  v_mfma_f32_16x16x32_bf16 v[248:251], v[240:243], v[120:123], v[248:251]
  v_exp_f32 v43, v43
  buffer_load_dwordx4 v10, s[32:35], s13 offen offset:0 nt lds
  buffer_load_dwordx4 v11, s[32:35], s13 offen offset:1024 nt lds
  s_add_u32 m0, s12, 106496
  v_mfma_f32_32x32x16_bf16 a[0:15], a[228:231], v[124:127], a[0:15]
  v_exp_f32 v44, v44
  v_cvt_pk_bf16_f32 v101, v42, v43
  s_mov_b32 s13, 40960
  buffer_load_dwordx4 v12, s[36:39], s13 offen offset:0 nt lds
  v_mfma_f32_32x32x16_bf16 a[16:31], a[236:239], v[124:127], a[16:31]
  v_exp_f32 v45, v45
  buffer_load_dwordx4 v12, s[36:39], s13 offen offset:1024 nt lds
  s_add_u32 m0, s12, 139264
  v_mfma_f32_32x32x16_bf16 a[32:47], a[244:247], v[124:127], a[32:47]
  v_exp_f32 v46, v46
  v_cvt_pk_bf16_f32 v102, v44, v45
  s_add_u32 s13, s70, 32768
  buffer_load_dwordx4 v13, s[48:51], s13 offen lds
  v_mfma_f32_32x32x16_bf16 a[48:63], a[252:255], v[124:127], a[48:63]
  v_mfma_f32_16x16x32_bf16 v[248:251], v[240:243], v[124:127], v[248:251]
  v_exp_f32 v47, v47
  s_add_u32 m0, s12, 140288
  s_add_u32 s13, s70, 36864
  buffer_load_dwordx4 v13, s[48:51], s13 offen lds
  s_nop 0
  v_cvt_pk_bf16_f32 v103, v46, v47
  s_waitcnt lgkmcnt(0)
  v_mfma_f32_32x32x16_bf16 v[64:79], a[192:195], a[128:131], v[128:143]
  s_waitcnt vmcnt(14) lgkmcnt(0)
  s_barrier
  v_exp_f32 v48, v48
  v_mfma_f32_32x32x16_bf16 v[64:79], a[196:199], a[132:135], v[64:79]
  v_exp_f32 v49, v49
  ds_read_b64_tr_b16 a[224:225], v24 offset:16384
  v_mfma_f32_32x32x16_bf16 v[64:79], a[200:203], a[136:139], v[64:79]
  v_exp_f32 v50, v50
  v_cvt_pk_bf16_f32 v104, v48, v49
  ds_read_b64_tr_b16 a[226:227], v24 offset:18432
  v_mfma_f32_32x32x16_bf16 v[64:79], a[204:207], a[140:143], v[64:79]
  v_exp_f32 v51, v51
  ds_read_b64_tr_b16 a[232:233], v25 offset:16384
  ds_read_b64_tr_b16 a[234:235], v25 offset:18432
  v_mfma_f32_32x32x16_bf16 v[64:79], a[208:211], a[144:147], v[64:79]
  v_exp_f32 v52, v52
  v_cvt_pk_bf16_f32 v105, v50, v51
  ds_read_b64_tr_b16 a[240:241], v26 offset:16384
  v_mfma_f32_32x32x16_bf16 v[64:79], a[212:215], a[148:151], v[64:79]
  v_exp_f32 v53, v53
  ds_read_b64_tr_b16 a[242:243], v26 offset:18432
  ds_read_b64_tr_b16 a[248:249], v27 offset:16384
  v_mfma_f32_32x32x16_bf16 v[64:79], a[216:219], a[152:155], v[64:79]
  v_exp_f32 v54, v54
  v_cvt_pk_bf16_f32 v106, v52, v53
  ds_read_b64_tr_b16 a[250:251], v27 offset:18432
  v_mfma_f32_32x32x16_bf16 v[64:79], a[220:223], a[156:159], v[64:79]
  v_exp_f32 v55, v55
  ds_read_b64_tr_b16 a[228:229], v24 offset:20480
  ds_read_b64_tr_b16 a[230:231], v24 offset:22528
  v_mfma_f32_32x32x16_bf16 v[80:95], a[192:195], a[160:163], v[144:159]
  v_exp_f32 v56, v56
  v_cvt_pk_bf16_f32 v107, v54, v55
  ds_read_b64_tr_b16 a[236:237], v25 offset:20480
  v_mfma_f32_32x32x16_bf16 v[80:95], a[196:199], a[164:167], v[80:95]
  v_exp_f32 v57, v57
  ds_read_b64_tr_b16 a[238:239], v25 offset:22528
  ds_read_b64_tr_b16 a[244:245], v26 offset:20480
  v_mfma_f32_32x32x16_bf16 v[80:95], a[200:203], a[168:171], v[80:95]
  v_exp_f32 v58, v58
  v_cvt_pk_bf16_f32 v108, v56, v57
  ds_read_b64_tr_b16 a[246:247], v26 offset:22528
  v_mfma_f32_32x32x16_bf16 v[80:95], a[204:207], a[172:175], v[80:95]
  v_exp_f32 v59, v59
  ds_read_b64_tr_b16 a[252:253], v27 offset:20480
  ds_read_b64_tr_b16 a[254:255], v27 offset:22528
  v_mfma_f32_32x32x16_bf16 v[80:95], a[208:211], a[176:179], v[80:95]
  v_exp_f32 v60, v60
  v_cvt_pk_bf16_f32 v109, v58, v59
  v_mfma_f32_32x32x16_bf16 v[80:95], a[212:215], a[180:183], v[80:95]
  v_exp_f32 v61, v61
  v_mfma_f32_32x32x16_bf16 v[80:95], a[216:219], a[184:187], v[80:95]
  v_exp_f32 v62, v62
  v_cvt_pk_bf16_f32 v110, v60, v61
  v_mfma_f32_32x32x16_bf16 v[80:95], a[220:223], a[188:191], v[80:95]
  v_exp_f32 v63, v63
  s_nop 0
  v_cvt_pk_bf16_f32 v111, v62, v63
  s_waitcnt lgkmcnt(0)
  v_mfma_f32_32x32x16_bf16 v[160:175], a[224:227], v[96:99], v[160:175]
  v_exp_f32 v64, v64
  ds_read_b128 a[192:195], v16 offset:32768
  v_mfma_f32_32x32x16_bf16 v[176:191], a[232:235], v[96:99], v[176:191]
  v_exp_f32 v65, v65
  ds_read_b128 a[196:199], v17 offset:32768
  v_mfma_f32_32x32x16_bf16 v[192:207], a[240:243], v[96:99], v[192:207]
  v_exp_f32 v66, v66
  v_cvt_pk_bf16_f32 v112, v64, v65
  ds_read_b128 a[200:203], v18 offset:32768
  v_mfma_f32_32x32x16_bf16 v[208:223], a[248:251], v[96:99], v[208:223]
  v_mfma_f32_16x16x32_bf16 v[244:247], v[240:243], v[96:99], v[244:247]
  v_exp_f32 v67, v67
  ds_read_b128 a[204:207], v19 offset:32768
  v_mfma_f32_32x32x16_bf16 v[160:175], a[228:231], v[100:103], v[160:175]
  v_exp_f32 v68, v68
  v_cvt_pk_bf16_f32 v113, v66, v67
  ds_read_b128 a[208:211], v20 offset:32768
  v_mfma_f32_32x32x16_bf16 v[176:191], a[236:239], v[100:103], v[176:191]
  v_exp_f32 v69, v69
  ds_read_b128 a[212:215], v21 offset:32768
  v_mfma_f32_32x32x16_bf16 v[192:207], a[244:247], v[100:103], v[192:207]
  v_exp_f32 v70, v70
  v_cvt_pk_bf16_f32 v114, v68, v69
  ds_read_b128 a[216:219], v22 offset:32768
  v_mfma_f32_32x32x16_bf16 v[208:223], a[252:255], v[100:103], v[208:223]
  v_mfma_f32_16x16x32_bf16 v[244:247], v[240:243], v[100:103], v[244:247]
  v_exp_f32 v71, v71
  ds_read_b128 a[220:223], v23 offset:32768
  v_mfma_f32_32x32x16_bf16 a[0:15], a[224:227], v[104:107], a[0:15]
  v_exp_f32 v72, v72
  v_cvt_pk_bf16_f32 v115, v70, v71
  s_add_u32 m0, s12, 0
  v_mfma_f32_32x32x16_bf16 a[16:31], a[232:235], v[104:107], a[16:31]
  v_exp_f32 v73, v73
  s_mov_b32 s13, 65536
  buffer_load_dwordx4 v10, s[32:35], s13 offen offset:0 nt lds
  v_mfma_f32_32x32x16_bf16 a[32:47], a[240:243], v[104:107], a[32:47]
  v_exp_f32 v74, v74
  v_cvt_pk_bf16_f32 v116, v72, v73
  buffer_load_dwordx4 v11, s[32:35], s13 offen offset:1024 nt lds
  s_add_u32 m0, s12, 114688
  v_mfma_f32_32x32x16_bf16 a[48:63], a[248:251], v[104:107], a[48:63]
  v_mfma_f32_16x16x32_bf16 v[248:251], v[240:243], v[104:107], v[248:251]
  v_exp_f32 v75, v75
  s_mov_b32 s13, 49152
  buffer_load_dwordx4 v12, s[36:39], s13 offen offset:0 nt lds
  v_mfma_f32_32x32x16_bf16 a[0:15], a[228:231], v[108:111], a[0:15]
  v_exp_f32 v76, v76
  v_cvt_pk_bf16_f32 v117, v74, v75
  buffer_load_dwordx4 v12, s[36:39], s13 offen offset:1024 nt lds
  v_mfma_f32_32x32x16_bf16 a[16:31], a[236:239], v[108:111], a[16:31]
  v_exp_f32 v77, v77
  s_add_u32 m0, s12, 147456
  s_add_u32 s13, s70, 65536
  v_mfma_f32_32x32x16_bf16 a[32:47], a[244:247], v[108:111], a[32:47]
  v_exp_f32 v78, v78
  v_cvt_pk_bf16_f32 v118, v76, v77
  buffer_load_dwordx4 v13, s[48:51], s13 offen lds
  s_add_u32 m0, s12, 148480
  v_mfma_f32_32x32x16_bf16 a[48:63], a[252:255], v[108:111], a[48:63]
  v_mfma_f32_16x16x32_bf16 v[248:251], v[240:243], v[108:111], v[248:251]
  v_exp_f32 v79, v79
  s_add_u32 s13, s70, 69632
  buffer_load_dwordx4 v13, s[48:51], s13 offen lds
  s_nop 0
  v_cvt_pk_bf16_f32 v119, v78, v79
  s_waitcnt lgkmcnt(0)
  v_mfma_f32_32x32x16_bf16 v[32:47], a[192:195], a[128:131], v[128:143]
  s_waitcnt vmcnt(18) lgkmcnt(0)
  s_barrier
  v_exp_f32 v80, v80
  v_mfma_f32_32x32x16_bf16 v[32:47], a[196:199], a[132:135], v[32:47]
  v_exp_f32 v81, v81
  ds_read_b64_tr_b16 a[224:225], v24 offset:24576
  v_mfma_f32_32x32x16_bf16 v[32:47], a[200:203], a[136:139], v[32:47]
  v_exp_f32 v82, v82
  v_cvt_pk_bf16_f32 v120, v80, v81
  ds_read_b64_tr_b16 a[226:227], v24 offset:26624
  v_mfma_f32_32x32x16_bf16 v[32:47], a[204:207], a[140:143], v[32:47]
  v_exp_f32 v83, v83
  ds_read_b64_tr_b16 a[232:233], v25 offset:24576
  ds_read_b64_tr_b16 a[234:235], v25 offset:26624
  v_mfma_f32_32x32x16_bf16 v[32:47], a[208:211], a[144:147], v[32:47]
  v_exp_f32 v84, v84
  v_cvt_pk_bf16_f32 v121, v82, v83
  ds_read_b64_tr_b16 a[240:241], v26 offset:24576
  v_mfma_f32_32x32x16_bf16 v[32:47], a[212:215], a[148:151], v[32:47]
  v_exp_f32 v85, v85
  ds_read_b64_tr_b16 a[242:243], v26 offset:26624
  ds_read_b64_tr_b16 a[248:249], v27 offset:24576
  v_mfma_f32_32x32x16_bf16 v[32:47], a[216:219], a[152:155], v[32:47]
  v_exp_f32 v86, v86
  v_cvt_pk_bf16_f32 v122, v84, v85
  ds_read_b64_tr_b16 a[250:251], v27 offset:26624
  v_mfma_f32_32x32x16_bf16 v[32:47], a[220:223], a[156:159], v[32:47]
  v_exp_f32 v87, v87
  ds_read_b64_tr_b16 a[228:229], v24 offset:28672
  ds_read_b64_tr_b16 a[230:231], v24 offset:30720
  v_mfma_f32_32x32x16_bf16 v[48:63], a[192:195], a[160:163], v[144:159]
  v_exp_f32 v88, v88
  v_cvt_pk_bf16_f32 v123, v86, v87
  ds_read_b64_tr_b16 a[236:237], v25 offset:28672
  v_mfma_f32_32x32x16_bf16 v[48:63], a[196:199], a[164:167], v[48:63]
  v_exp_f32 v89, v89
  ds_read_b64_tr_b16 a[238:239], v25 offset:30720
  ds_read_b64_tr_b16 a[244:245], v26 offset:28672
  v_mfma_f32_32x32x16_bf16 v[48:63], a[200:203], a[168:171], v[48:63]
  v_exp_f32 v90, v90
  v_cvt_pk_bf16_f32 v124, v88, v89
  ds_read_b64_tr_b16 a[246:247], v26 offset:30720
  v_mfma_f32_32x32x16_bf16 v[48:63], a[204:207], a[172:175], v[48:63]
  v_exp_f32 v91, v91
  ds_read_b64_tr_b16 a[252:253], v27 offset:28672
  ds_read_b64_tr_b16 a[254:255], v27 offset:30720
  v_mfma_f32_32x32x16_bf16 v[48:63], a[208:211], a[176:179], v[48:63]
  v_exp_f32 v92, v92
  v_cvt_pk_bf16_f32 v125, v90, v91
  v_mfma_f32_32x32x16_bf16 v[48:63], a[212:215], a[180:183], v[48:63]
  v_exp_f32 v93, v93
  v_mfma_f32_32x32x16_bf16 v[48:63], a[216:219], a[184:187], v[48:63]
  v_exp_f32 v94, v94
  v_cvt_pk_bf16_f32 v126, v92, v93
  v_mfma_f32_32x32x16_bf16 v[48:63], a[220:223], a[188:191], v[48:63]
  v_exp_f32 v95, v95
  s_nop 0
  v_cvt_pk_bf16_f32 v127, v94, v95
  s_waitcnt lgkmcnt(0)
  v_mfma_f32_32x32x16_bf16 v[160:175], a[224:227], v[112:115], v[160:175]
  v_exp_f32 v32, v32
  ds_read_b128 a[192:195], v16 offset:40960
  v_mfma_f32_32x32x16_bf16 v[176:191], a[232:235], v[112:115], v[176:191]
  v_exp_f32 v33, v33
  ds_read_b128 a[196:199], v17 offset:40960
  v_mfma_f32_32x32x16_bf16 v[192:207], a[240:243], v[112:115], v[192:207]
  v_exp_f32 v34, v34
  v_cvt_pk_bf16_f32 v96, v32, v33
  ds_read_b128 a[200:203], v18 offset:40960
  v_mfma_f32_32x32x16_bf16 v[208:223], a[248:251], v[112:115], v[208:223]
  v_mfma_f32_16x16x32_bf16 v[244:247], v[240:243], v[112:115], v[244:247]
  v_exp_f32 v35, v35
  ds_read_b128 a[204:207], v19 offset:40960
  v_mfma_f32_32x32x16_bf16 v[160:175], a[228:231], v[116:119], v[160:175]
  v_exp_f32 v36, v36
  v_cvt_pk_bf16_f32 v97, v34, v35
  ds_read_b128 a[208:211], v20 offset:40960
  v_mfma_f32_32x32x16_bf16 v[176:191], a[236:239], v[116:119], v[176:191]
  v_exp_f32 v37, v37
  ds_read_b128 a[212:215], v21 offset:40960
  v_mfma_f32_32x32x16_bf16 v[192:207], a[244:247], v[116:119], v[192:207]
  v_exp_f32 v38, v38
  v_cvt_pk_bf16_f32 v98, v36, v37
  ds_read_b128 a[216:219], v22 offset:40960
  v_mfma_f32_32x32x16_bf16 v[208:223], a[252:255], v[116:119], v[208:223]
  v_mfma_f32_16x16x32_bf16 v[244:247], v[240:243], v[116:119], v[244:247]
  v_exp_f32 v39, v39
  ds_read_b128 a[220:223], v23 offset:40960
  v_mfma_f32_32x32x16_bf16 a[0:15], a[224:227], v[120:123], a[0:15]
  v_exp_f32 v40, v40
  v_cvt_pk_bf16_f32 v99, v38, v39
  s_add_u32 m0, s12, 8192
  v_mfma_f32_32x32x16_bf16 a[16:31], a[232:235], v[120:123], a[16:31]
  v_exp_f32 v41, v41
  s_mov_b32 s13, 73728
  buffer_load_dwordx4 v10, s[32:35], s13 offen offset:0 nt lds
  v_mfma_f32_32x32x16_bf16 a[32:47], a[240:243], v[120:123], a[32:47]
  v_exp_f32 v42, v42
  v_cvt_pk_bf16_f32 v100, v40, v41
  buffer_load_dwordx4 v11, s[32:35], s13 offen offset:1024 nt lds
  s_add_u32 m0, s12, 122880
  v_mfma_f32_32x32x16_bf16 a[48:63], a[248:251], v[120:123], a[48:63]
  v_mfma_f32_16x16x32_bf16 v[248:251], v[240:243], v[120:123], v[248:251]
  v_exp_f32 v43, v43
  s_mov_b32 s13, 57344
  buffer_load_dwordx4 v12, s[36:39], s13 offen offset:0 nt lds
  v_mfma_f32_32x32x16_bf16 a[0:15], a[228:231], v[124:127], a[0:15]
  v_exp_f32 v44, v44
  v_cvt_pk_bf16_f32 v101, v42, v43
  buffer_load_dwordx4 v12, s[36:39], s13 offen offset:1024 nt lds
  v_mfma_f32_32x32x16_bf16 a[16:31], a[236:239], v[124:127], a[16:31]
  v_exp_f32 v45, v45
  s_add_u32 m0, s12, 155648
  s_add_u32 s13, s70, 98304
  v_mfma_f32_32x32x16_bf16 a[32:47], a[244:247], v[124:127], a[32:47]
  v_exp_f32 v46, v46
  v_cvt_pk_bf16_f32 v102, v44, v45
  buffer_load_dwordx4 v13, s[48:51], s13 offen lds
  s_add_u32 m0, s12, 156672
  v_mfma_f32_32x32x16_bf16 a[48:63], a[252:255], v[124:127], a[48:63]
  v_mfma_f32_16x16x32_bf16 v[248:251], v[240:243], v[124:127], v[248:251]
  v_exp_f32 v47, v47
  s_add_u32 s13, s70, 102400
  buffer_load_dwordx4 v13, s[48:51], s13 offen lds
  s_nop 0
  v_cvt_pk_bf16_f32 v103, v46, v47
  s_waitcnt lgkmcnt(0)
  v_mfma_f32_32x32x16_bf16 v[64:79], a[192:195], a[128:131], v[128:143]
  s_waitcnt vmcnt(18) lgkmcnt(0)
  s_barrier
  v_exp_f32 v48, v48
  v_mfma_f32_32x32x16_bf16 v[64:79], a[196:199], a[132:135], v[64:79]
  v_exp_f32 v49, v49
  ds_read_b64_tr_b16 a[224:225], v24 offset:32768
  v_mfma_f32_32x32x16_bf16 v[64:79], a[200:203], a[136:139], v[64:79]
  v_exp_f32 v50, v50
  v_cvt_pk_bf16_f32 v104, v48, v49
  ds_read_b64_tr_b16 a[226:227], v24 offset:34816
  v_mfma_f32_32x32x16_bf16 v[64:79], a[204:207], a[140:143], v[64:79]
  v_exp_f32 v51, v51
  ds_read_b64_tr_b16 a[232:233], v25 offset:32768
  ds_read_b64_tr_b16 a[234:235], v25 offset:34816
  v_mfma_f32_32x32x16_bf16 v[64:79], a[208:211], a[144:147], v[64:79]
  v_exp_f32 v52, v52
  v_cvt_pk_bf16_f32 v105, v50, v51
  ds_read_b64_tr_b16 a[240:241], v26 offset:32768
  v_mfma_f32_32x32x16_bf16 v[64:79], a[212:215], a[148:151], v[64:79]
  v_exp_f32 v53, v53
  ds_read_b64_tr_b16 a[242:243], v26 offset:34816
  ds_read_b64_tr_b16 a[248:249], v27 offset:32768
  v_mfma_f32_32x32x16_bf16 v[64:79], a[216:219], a[152:155], v[64:79]
  v_exp_f32 v54, v54
  v_cvt_pk_bf16_f32 v106, v52, v53
  ds_read_b64_tr_b16 a[250:251], v27 offset:34816
  v_mfma_f32_32x32x16_bf16 v[64:79], a[220:223], a[156:159], v[64:79]
  v_exp_f32 v55, v55
  ds_read_b64_tr_b16 a[228:229], v24 offset:36864
  ds_read_b64_tr_b16 a[230:231], v24 offset:38912
  v_mfma_f32_32x32x16_bf16 v[80:95], a[192:195], a[160:163], v[144:159]
  v_exp_f32 v56, v56
  v_cvt_pk_bf16_f32 v107, v54, v55
  ds_read_b64_tr_b16 a[236:237], v25 offset:36864
  v_mfma_f32_32x32x16_bf16 v[80:95], a[196:199], a[164:167], v[80:95]
  v_exp_f32 v57, v57
  ds_read_b64_tr_b16 a[238:239], v25 offset:38912
  ds_read_b64_tr_b16 a[244:245], v26 offset:36864
  v_mfma_f32_32x32x16_bf16 v[80:95], a[200:203], a[168:171], v[80:95]
  v_exp_f32 v58, v58
  v_cvt_pk_bf16_f32 v108, v56, v57
  ds_read_b64_tr_b16 a[246:247], v26 offset:38912
  v_mfma_f32_32x32x16_bf16 v[80:95], a[204:207], a[172:175], v[80:95]
  v_exp_f32 v59, v59
  ds_read_b64_tr_b16 a[252:253], v27 offset:36864
  ds_read_b64_tr_b16 a[254:255], v27 offset:38912
  v_mfma_f32_32x32x16_bf16 v[80:95], a[208:211], a[176:179], v[80:95]
  v_exp_f32 v60, v60
  v_cvt_pk_bf16_f32 v109, v58, v59
  v_mfma_f32_32x32x16_bf16 v[80:95], a[212:215], a[180:183], v[80:95]
  v_exp_f32 v61, v61
  v_mfma_f32_32x32x16_bf16 v[80:95], a[216:219], a[184:187], v[80:95]
  v_exp_f32 v62, v62
  v_cvt_pk_bf16_f32 v110, v60, v61
  v_mfma_f32_32x32x16_bf16 v[80:95], a[220:223], a[188:191], v[80:95]
  v_exp_f32 v63, v63
  s_nop 0
  v_cvt_pk_bf16_f32 v111, v62, v63
  s_waitcnt lgkmcnt(0)
  v_mfma_f32_32x32x16_bf16 v[160:175], a[224:227], v[96:99], v[160:175]
  v_exp_f32 v64, v64
  ds_read_b128 a[192:195], v16 offset:49152
  v_mfma_f32_32x32x16_bf16 v[176:191], a[232:235], v[96:99], v[176:191]
  v_exp_f32 v65, v65
  ds_read_b128 a[196:199], v17 offset:49152
  v_mfma_f32_32x32x16_bf16 v[192:207], a[240:243], v[96:99], v[192:207]
  v_exp_f32 v66, v66
  v_cvt_pk_bf16_f32 v112, v64, v65
  ds_read_b128 a[200:203], v18 offset:49152
  v_mfma_f32_32x32x16_bf16 v[208:223], a[248:251], v[96:99], v[208:223]
  v_mfma_f32_16x16x32_bf16 v[244:247], v[240:243], v[96:99], v[244:247]
  v_exp_f32 v67, v67
  ds_read_b128 a[204:207], v19 offset:49152
  v_mfma_f32_32x32x16_bf16 v[160:175], a[228:231], v[100:103], v[160:175]
  v_exp_f32 v68, v68
  v_cvt_pk_bf16_f32 v113, v66, v67
  ds_read_b128 a[208:211], v20 offset:49152
  v_mfma_f32_32x32x16_bf16 v[176:191], a[236:239], v[100:103], v[176:191]
  v_exp_f32 v69, v69
  ds_read_b128 a[212:215], v21 offset:49152
  v_mfma_f32_32x32x16_bf16 v[192:207], a[244:247], v[100:103], v[192:207]
  v_exp_f32 v70, v70
  v_cvt_pk_bf16_f32 v114, v68, v69
  ds_read_b128 a[216:219], v22 offset:49152
  v_mfma_f32_32x32x16_bf16 v[208:223], a[252:255], v[100:103], v[208:223]
  v_mfma_f32_16x16x32_bf16 v[244:247], v[240:243], v[100:103], v[244:247]
  v_exp_f32 v71, v71
  ds_read_b128 a[220:223], v23 offset:49152
  v_mfma_f32_32x32x16_bf16 a[0:15], a[224:227], v[104:107], a[0:15]
  v_exp_f32 v72, v72
  v_cvt_pk_bf16_f32 v115, v70, v71
  s_add_u32 m0, s12, 16384
  v_mfma_f32_32x32x16_bf16 a[16:31], a[232:235], v[104:107], a[16:31]
  v_exp_f32 v73, v73
  s_mov_b32 s13, 81920
  v_mfma_f32_32x32x16_bf16 a[32:47], a[240:243], v[104:107], a[32:47]
  v_exp_f32 v74, v74
  v_cvt_pk_bf16_f32 v116, v72, v73
  buffer_load_dwordx4 v10, s[32:35], s13 offen offset:0 nt lds
  v_mfma_f32_32x32x16_bf16 a[48:63], a[248:251], v[104:107], a[48:63]
  v_mfma_f32_16x16x32_bf16 v[248:251], v[240:243], v[104:107], v[248:251]
  v_exp_f32 v75, v75
  buffer_load_dwordx4 v11, s[32:35], s13 offen offset:1024 nt lds
  v_mfma_f32_32x32x16_bf16 a[0:15], a[228:231], v[108:111], a[0:15]
  v_exp_f32 v76, v76
  v_cvt_pk_bf16_f32 v117, v74, v75
  s_add_u32 m0, s12, 65536
  v_mfma_f32_32x32x16_bf16 a[16:31], a[236:239], v[108:111], a[16:31]
  v_exp_f32 v77, v77
  s_mov_b32 s13, 65536
  v_mfma_f32_32x32x16_bf16 a[32:47], a[244:247], v[108:111], a[32:47]
  v_exp_f32 v78, v78
  v_cvt_pk_bf16_f32 v118, v76, v77
  buffer_load_dwordx4 v12, s[36:39], s13 offen offset:0 nt lds
  v_mfma_f32_32x32x16_bf16 a[48:63], a[252:255], v[108:111], a[48:63]
  v_mfma_f32_16x16x32_bf16 v[248:251], v[240:243], v[108:111], v[248:251]
  v_exp_f32 v79, v79
  buffer_load_dwordx4 v12, s[36:39], s13 offen offset:1024 nt lds
  s_nop 0
  v_cvt_pk_bf16_f32 v119, v78, v79
  s_waitcnt lgkmcnt(0)
  v_mfma_f32_32x32x16_bf16 v[32:47], a[192:195], a[128:131], v[128:143]
  s_waitcnt vmcnt(18) lgkmcnt(0)
  s_barrier
  v_exp_f32 v80, v80
  v_mfma_f32_32x32x16_bf16 v[32:47], a[196:199], a[132:135], v[32:47]
  v_exp_f32 v81, v81
  ds_read_b64_tr_b16 a[224:225], v24 offset:40960
  v_mfma_f32_32x32x16_bf16 v[32:47], a[200:203], a[136:139], v[32:47]
  v_exp_f32 v82, v82
  v_cvt_pk_bf16_f32 v120, v80, v81
  ds_read_b64_tr_b16 a[226:227], v24 offset:43008
  v_mfma_f32_32x32x16_bf16 v[32:47], a[204:207], a[140:143], v[32:47]
  v_exp_f32 v83, v83
  ds_read_b64_tr_b16 a[232:233], v25 offset:40960
  ds_read_b64_tr_b16 a[234:235], v25 offset:43008
  v_mfma_f32_32x32x16_bf16 v[32:47], a[208:211], a[144:147], v[32:47]
  v_exp_f32 v84, v84
  v_cvt_pk_bf16_f32 v121, v82, v83
  ds_read_b64_tr_b16 a[240:241], v26 offset:40960
  v_mfma_f32_32x32x16_bf16 v[32:47], a[212:215], a[148:151], v[32:47]
  v_exp_f32 v85, v85
  ds_read_b64_tr_b16 a[242:243], v26 offset:43008
  ds_read_b64_tr_b16 a[248:249], v27 offset:40960
  v_mfma_f32_32x32x16_bf16 v[32:47], a[216:219], a[152:155], v[32:47]
  v_exp_f32 v86, v86
  v_cvt_pk_bf16_f32 v122, v84, v85
  ds_read_b64_tr_b16 a[250:251], v27 offset:43008
  v_mfma_f32_32x32x16_bf16 v[32:47], a[220:223], a[156:159], v[32:47]
  v_exp_f32 v87, v87
  ds_read_b64_tr_b16 a[228:229], v24 offset:45056
  ds_read_b64_tr_b16 a[230:231], v24 offset:47104
  v_mfma_f32_32x32x16_bf16 v[48:63], a[192:195], a[160:163], v[144:159]
  v_exp_f32 v88, v88
  v_cvt_pk_bf16_f32 v123, v86, v87
  ds_read_b64_tr_b16 a[236:237], v25 offset:45056
  v_mfma_f32_32x32x16_bf16 v[48:63], a[196:199], a[164:167], v[48:63]
  v_exp_f32 v89, v89
  ds_read_b64_tr_b16 a[238:239], v25 offset:47104
  ds_read_b64_tr_b16 a[244:245], v26 offset:45056
  v_mfma_f32_32x32x16_bf16 v[48:63], a[200:203], a[168:171], v[48:63]
  v_exp_f32 v90, v90
  v_cvt_pk_bf16_f32 v124, v88, v89
  ds_read_b64_tr_b16 a[246:247], v26 offset:47104
  v_mfma_f32_32x32x16_bf16 v[48:63], a[204:207], a[172:175], v[48:63]
  v_exp_f32 v91, v91
  ds_read_b64_tr_b16 a[252:253], v27 offset:45056
  ds_read_b64_tr_b16 a[254:255], v27 offset:47104
  v_mfma_f32_32x32x16_bf16 v[48:63], a[208:211], a[176:179], v[48:63]
  v_exp_f32 v92, v92
  v_cvt_pk_bf16_f32 v125, v90, v91
  v_mfma_f32_32x32x16_bf16 v[48:63], a[212:215], a[180:183], v[48:63]
  v_exp_f32 v93, v93
  v_mfma_f32_32x32x16_bf16 v[48:63], a[216:219], a[184:187], v[48:63]
  v_exp_f32 v94, v94
  v_cvt_pk_bf16_f32 v126, v92, v93
  v_mfma_f32_32x32x16_bf16 v[48:63], a[220:223], a[188:191], v[48:63]
  v_exp_f32 v95, v95
  s_nop 0
  v_cvt_pk_bf16_f32 v127, v94, v95
  s_waitcnt lgkmcnt(0)
  v_mfma_f32_32x32x16_bf16 v[160:175], a[224:227], v[112:115], v[160:175]
  v_exp_f32 v32, v32
  ds_read_b128 a[192:195], v16 offset:57344
  v_mfma_f32_32x32x16_bf16 v[176:191], a[232:235], v[112:115], v[176:191]
  v_exp_f32 v33, v33
  ds_read_b128 a[196:199], v17 offset:57344
  v_mfma_f32_32x32x16_bf16 v[192:207], a[240:243], v[112:115], v[192:207]
  v_exp_f32 v34, v34
  v_cvt_pk_bf16_f32 v96, v32, v33
  ds_read_b128 a[200:203], v18 offset:57344
  v_mfma_f32_32x32x16_bf16 v[208:223], a[248:251], v[112:115], v[208:223]
  v_mfma_f32_16x16x32_bf16 v[244:247], v[240:243], v[112:115], v[244:247]
  v_exp_f32 v35, v35
  ds_read_b128 a[204:207], v19 offset:57344
  v_mfma_f32_32x32x16_bf16 v[160:175], a[228:231], v[116:119], v[160:175]
  v_exp_f32 v36, v36
  v_cvt_pk_bf16_f32 v97, v34, v35
  ds_read_b128 a[208:211], v20 offset:57344
  v_mfma_f32_32x32x16_bf16 v[176:191], a[236:239], v[116:119], v[176:191]
  v_exp_f32 v37, v37
  ds_read_b128 a[212:215], v21 offset:57344
  v_mfma_f32_32x32x16_bf16 v[192:207], a[244:247], v[116:119], v[192:207]
  v_exp_f32 v38, v38
  v_cvt_pk_bf16_f32 v98, v36, v37
  ds_read_b128 a[216:219], v22 offset:57344
  v_mfma_f32_32x32x16_bf16 v[208:223], a[252:255], v[116:119], v[208:223]
  v_mfma_f32_16x16x32_bf16 v[244:247], v[240:243], v[116:119], v[244:247]
  v_exp_f32 v39, v39
  ds_read_b128 a[220:223], v23 offset:57344
  v_mfma_f32_32x32x16_bf16 a[0:15], a[224:227], v[120:123], a[0:15]
  v_exp_f32 v40, v40
  v_cvt_pk_bf16_f32 v99, v38, v39
  s_add_u32 m0, s12, 24576
  v_mfma_f32_32x32x16_bf16 a[16:31], a[232:235], v[120:123], a[16:31]
  v_exp_f32 v41, v41
  s_mov_b32 s13, 90112
  v_mfma_f32_32x32x16_bf16 a[32:47], a[240:243], v[120:123], a[32:47]
  v_exp_f32 v42, v42
  v_cvt_pk_bf16_f32 v100, v40, v41
  buffer_load_dwordx4 v10, s[32:35], s13 offen offset:0 nt lds
  v_mfma_f32_32x32x16_bf16 a[48:63], a[248:251], v[120:123], a[48:63]
  v_mfma_f32_16x16x32_bf16 v[248:251], v[240:243], v[120:123], v[248:251]
  v_exp_f32 v43, v43
  buffer_load_dwordx4 v11, s[32:35], s13 offen offset:1024 nt lds
  v_mfma_f32_32x32x16_bf16 a[0:15], a[228:231], v[124:127], a[0:15]
  v_exp_f32 v44, v44
  v_cvt_pk_bf16_f32 v101, v42, v43
  s_add_u32 m0, s12, 73728
  v_mfma_f32_32x32x16_bf16 a[16:31], a[236:239], v[124:127], a[16:31]
  v_exp_f32 v45, v45
  s_mov_b32 s13, 73728
  v_mfma_f32_32x32x16_bf16 a[32:47], a[244:247], v[124:127], a[32:47]
  v_exp_f32 v46, v46
  v_cvt_pk_bf16_f32 v102, v44, v45
  buffer_load_dwordx4 v12, s[36:39], s13 offen offset:0 nt lds
  v_mfma_f32_32x32x16_bf16 a[48:63], a[252:255], v[124:127], a[48:63]
  v_mfma_f32_16x16x32_bf16 v[248:251], v[240:243], v[124:127], v[248:251]
  v_exp_f32 v47, v47
  buffer_load_dwordx4 v12, s[36:39], s13 offen offset:1024 nt lds
  s_nop 0
  v_cvt_pk_bf16_f32 v103, v46, v47
  s_waitcnt lgkmcnt(0)
  v_mfma_f32_32x32x16_bf16 v[64:79], a[192:195], a[128:131], v[128:143]
  s_waitcnt vmcnt(16) lgkmcnt(0)
  s_barrier
  v_exp_f32 v48, v48
  v_mfma_f32_32x32x16_bf16 v[64:79], a[196:199], a[132:135], v[64:79]
  v_exp_f32 v49, v49
  ds_read_b64_tr_b16 a[224:225], v24 offset:49152
  v_mfma_f32_32x32x16_bf16 v[64:79], a[200:203], a[136:139], v[64:79]
  v_exp_f32 v50, v50
  v_cvt_pk_bf16_f32 v104, v48, v49
  ds_read_b64_tr_b16 a[226:227], v24 offset:51200
  v_mfma_f32_32x32x16_bf16 v[64:79], a[204:207], a[140:143], v[64:79]
  v_exp_f32 v51, v51
  ds_read_b64_tr_b16 a[232:233], v25 offset:49152
  ds_read_b64_tr_b16 a[234:235], v25 offset:51200
  v_mfma_f32_32x32x16_bf16 v[64:79], a[208:211], a[144:147], v[64:79]
  v_exp_f32 v52, v52
  v_cvt_pk_bf16_f32 v105, v50, v51
  ds_read_b64_tr_b16 a[240:241], v26 offset:49152
  v_mfma_f32_32x32x16_bf16 v[64:79], a[212:215], a[148:151], v[64:79]
  v_exp_f32 v53, v53
  ds_read_b64_tr_b16 a[242:243], v26 offset:51200
  ds_read_b64_tr_b16 a[248:249], v27 offset:49152
  v_mfma_f32_32x32x16_bf16 v[64:79], a[216:219], a[152:155], v[64:79]
  v_exp_f32 v54, v54
  v_cvt_pk_bf16_f32 v106, v52, v53
  ds_read_b64_tr_b16 a[250:251], v27 offset:51200
  v_mfma_f32_32x32x16_bf16 v[64:79], a[220:223], a[156:159], v[64:79]
  v_exp_f32 v55, v55
  ds_read_b64_tr_b16 a[228:229], v24 offset:53248
  ds_read_b64_tr_b16 a[230:231], v24 offset:55296
  v_mfma_f32_32x32x16_bf16 v[80:95], a[192:195], a[160:163], v[144:159]
  v_exp_f32 v56, v56
  v_cvt_pk_bf16_f32 v107, v54, v55
  ds_read_b64_tr_b16 a[236:237], v25 offset:53248
  v_mfma_f32_32x32x16_bf16 v[80:95], a[196:199], a[164:167], v[80:95]
  v_exp_f32 v57, v57
  ds_read_b64_tr_b16 a[238:239], v25 offset:55296
  ds_read_b64_tr_b16 a[244:245], v26 offset:53248
  v_mfma_f32_32x32x16_bf16 v[80:95], a[200:203], a[168:171], v[80:95]
  v_exp_f32 v58, v58
  v_cvt_pk_bf16_f32 v108, v56, v57
  ds_read_b64_tr_b16 a[246:247], v26 offset:55296
  v_mfma_f32_32x32x16_bf16 v[80:95], a[204:207], a[172:175], v[80:95]
  v_exp_f32 v59, v59
  ds_read_b64_tr_b16 a[252:253], v27 offset:53248
  ds_read_b64_tr_b16 a[254:255], v27 offset:55296
  v_mfma_f32_32x32x16_bf16 v[80:95], a[208:211], a[176:179], v[80:95]
  v_exp_f32 v60, v60
  v_cvt_pk_bf16_f32 v109, v58, v59
  v_mfma_f32_32x32x16_bf16 v[80:95], a[212:215], a[180:183], v[80:95]
  v_exp_f32 v61, v61
  v_mfma_f32_32x32x16_bf16 v[80:95], a[216:219], a[184:187], v[80:95]
  v_exp_f32 v62, v62
  v_cvt_pk_bf16_f32 v110, v60, v61
  v_mfma_f32_32x32x16_bf16 v[80:95], a[220:223], a[188:191], v[80:95]
  v_exp_f32 v63, v63
  s_nop 0
  v_cvt_pk_bf16_f32 v111, v62, v63
  s_waitcnt lgkmcnt(0)
  v_mfma_f32_32x32x16_bf16 v[160:175], a[224:227], v[96:99], v[160:175]
  v_exp_f32 v64, v64
  ds_read_b128 a[192:195], v16 offset:0
  v_mfma_f32_32x32x16_bf16 v[176:191], a[232:235], v[96:99], v[176:191]
  v_exp_f32 v65, v65
  ds_read_b128 a[196:199], v17 offset:0
  v_mfma_f32_32x32x16_bf16 v[192:207], a[240:243], v[96:99], v[192:207]
  v_exp_f32 v66, v66
  v_cvt_pk_bf16_f32 v112, v64, v65
  ds_read_b128 a[200:203], v18 offset:0
  v_mfma_f32_32x32x16_bf16 v[208:223], a[248:251], v[96:99], v[208:223]
  v_mfma_f32_16x16x32_bf16 v[244:247], v[240:243], v[96:99], v[244:247]
  v_exp_f32 v67, v67
  ds_read_b128 a[204:207], v19 offset:0
  v_mfma_f32_32x32x16_bf16 v[160:175], a[228:231], v[100:103], v[160:175]
  v_exp_f32 v68, v68
  v_cvt_pk_bf16_f32 v113, v66, v67
  ds_read_b128 a[208:211], v20 offset:0
  v_mfma_f32_32x32x16_bf16 v[176:191], a[236:239], v[100:103], v[176:191]
  v_exp_f32 v69, v69
  ds_read_b128 a[212:215], v21 offset:0
  v_mfma_f32_32x32x16_bf16 v[192:207], a[244:247], v[100:103], v[192:207]
  v_exp_f32 v70, v70
  v_cvt_pk_bf16_f32 v114, v68, v69
  ds_read_b128 a[216:219], v22 offset:0
  v_mfma_f32_32x32x16_bf16 v[208:223], a[252:255], v[100:103], v[208:223]
  v_mfma_f32_16x16x32_bf16 v[244:247], v[240:243], v[100:103], v[244:247]
  v_exp_f32 v71, v71
  ds_read_b128 a[220:223], v23 offset:0
  v_mfma_f32_32x32x16_bf16 a[0:15], a[224:227], v[104:107], a[0:15]
  v_exp_f32 v72, v72
  v_cvt_pk_bf16_f32 v115, v70, v71
  s_add_u32 m0, s12, 32768
  v_mfma_f32_32x32x16_bf16 a[16:31], a[232:235], v[104:107], a[16:31]
  v_exp_f32 v73, v73
  s_mov_b32 s13, 98304
  v_mfma_f32_32x32x16_bf16 a[32:47], a[240:243], v[104:107], a[32:47]
  v_exp_f32 v74, v74
  v_cvt_pk_bf16_f32 v116, v72, v73
  buffer_load_dwordx4 v10, s[32:35], s13 offen offset:0 nt lds
  v_mfma_f32_32x32x16_bf16 a[48:63], a[248:251], v[104:107], a[48:63]
  v_mfma_f32_16x16x32_bf16 v[248:251], v[240:243], v[104:107], v[248:251]
  v_exp_f32 v75, v75
  buffer_load_dwordx4 v11, s[32:35], s13 offen offset:1024 nt lds
  v_mfma_f32_32x32x16_bf16 a[0:15], a[228:231], v[108:111], a[0:15]
  v_exp_f32 v76, v76
  v_cvt_pk_bf16_f32 v117, v74, v75
  s_add_u32 m0, s12, 81920
  v_mfma_f32_32x32x16_bf16 a[16:31], a[236:239], v[108:111], a[16:31]
  v_exp_f32 v77, v77
  s_mov_b32 s13, 81920
  v_mfma_f32_32x32x16_bf16 a[32:47], a[244:247], v[108:111], a[32:47]
  v_exp_f32 v78, v78
  v_cvt_pk_bf16_f32 v118, v76, v77
  buffer_load_dwordx4 v12, s[36:39], s13 offen offset:0 nt lds
  v_mfma_f32_32x32x16_bf16 a[48:63], a[252:255], v[108:111], a[48:63]
  v_mfma_f32_16x16x32_bf16 v[248:251], v[240:243], v[108:111], v[248:251]
  v_exp_f32 v79, v79
  buffer_load_dwordx4 v12, s[36:39], s13 offen offset:1024 nt lds
  s_nop 0
  v_cvt_pk_bf16_f32 v119, v78, v79
  s_waitcnt lgkmcnt(0)
  v_mfma_f32_32x32x16_bf16 v[32:47], a[192:195], a[128:131], v[128:143]
  s_waitcnt vmcnt(14) lgkmcnt(0)
  s_barrier
  v_exp_f32 v80, v80
  v_mfma_f32_32x32x16_bf16 v[32:47], a[196:199], a[132:135], v[32:47]
  v_exp_f32 v81, v81
  ds_read_b64_tr_b16 a[224:225], v24 offset:57344
  v_mfma_f32_32x32x16_bf16 v[32:47], a[200:203], a[136:139], v[32:47]
  v_exp_f32 v82, v82
  v_cvt_pk_bf16_f32 v120, v80, v81
  ds_read_b64_tr_b16 a[226:227], v24 offset:59392
  v_mfma_f32_32x32x16_bf16 v[32:47], a[204:207], a[140:143], v[32:47]
  v_exp_f32 v83, v83
  ds_read_b64_tr_b16 a[232:233], v25 offset:57344
  ds_read_b64_tr_b16 a[234:235], v25 offset:59392
  v_mfma_f32_32x32x16_bf16 v[32:47], a[208:211], a[144:147], v[32:47]
  v_exp_f32 v84, v84
  v_cvt_pk_bf16_f32 v121, v82, v83
  ds_read_b64_tr_b16 a[240:241], v26 offset:57344
  v_mfma_f32_32x32x16_bf16 v[32:47], a[212:215], a[148:151], v[32:47]
  v_exp_f32 v85, v85
  ds_read_b64_tr_b16 a[242:243], v26 offset:59392
  ds_read_b64_tr_b16 a[248:249], v27 offset:57344
  v_mfma_f32_32x32x16_bf16 v[32:47], a[216:219], a[152:155], v[32:47]
  v_exp_f32 v86, v86
  v_cvt_pk_bf16_f32 v122, v84, v85
  ds_read_b64_tr_b16 a[250:251], v27 offset:59392
  v_mfma_f32_32x32x16_bf16 v[32:47], a[220:223], a[156:159], v[32:47]
  v_exp_f32 v87, v87
  ds_read_b64_tr_b16 a[228:229], v24 offset:61440
  ds_read_b64_tr_b16 a[230:231], v24 offset:63488
  v_mfma_f32_32x32x16_bf16 v[48:63], a[192:195], a[160:163], v[144:159]
  v_exp_f32 v88, v88
  v_cvt_pk_bf16_f32 v123, v86, v87
  ds_read_b64_tr_b16 a[236:237], v25 offset:61440
  v_mfma_f32_32x32x16_bf16 v[48:63], a[196:199], a[164:167], v[48:63]
  v_exp_f32 v89, v89
  ds_read_b64_tr_b16 a[238:239], v25 offset:63488
  ds_read_b64_tr_b16 a[244:245], v26 offset:61440
  v_mfma_f32_32x32x16_bf16 v[48:63], a[200:203], a[168:171], v[48:63]
  v_exp_f32 v90, v90
  v_cvt_pk_bf16_f32 v124, v88, v89
  ds_read_b64_tr_b16 a[246:247], v26 offset:63488
  v_mfma_f32_32x32x16_bf16 v[48:63], a[204:207], a[172:175], v[48:63]
  v_exp_f32 v91, v91
  ds_read_b64_tr_b16 a[252:253], v27 offset:61440
  ds_read_b64_tr_b16 a[254:255], v27 offset:63488
  v_mfma_f32_32x32x16_bf16 v[48:63], a[208:211], a[176:179], v[48:63]
  v_exp_f32 v92, v92
  v_cvt_pk_bf16_f32 v125, v90, v91
  v_mfma_f32_32x32x16_bf16 v[48:63], a[212:215], a[180:183], v[48:63]
  v_exp_f32 v93, v93
  v_mfma_f32_32x32x16_bf16 v[48:63], a[216:219], a[184:187], v[48:63]
  v_exp_f32 v94, v94
  v_cvt_pk_bf16_f32 v126, v92, v93
  v_mfma_f32_32x32x16_bf16 v[48:63], a[220:223], a[188:191], v[48:63]
  v_exp_f32 v95, v95
  s_nop 0
  v_cvt_pk_bf16_f32 v127, v94, v95
  s_waitcnt lgkmcnt(0)
  v_mfma_f32_32x32x16_bf16 v[160:175], a[224:227], v[112:115], v[160:175]
  v_exp_f32 v32, v32
  ds_read_b128 a[192:195], v16 offset:8192
  v_mfma_f32_32x32x16_bf16 v[176:191], a[232:235], v[112:115], v[176:191]
  v_exp_f32 v33, v33
  ds_read_b128 a[196:199], v17 offset:8192
  v_mfma_f32_32x32x16_bf16 v[192:207], a[240:243], v[112:115], v[192:207]
  v_exp_f32 v34, v34
  v_cvt_pk_bf16_f32 v96, v32, v33
  ds_read_b128 a[200:203], v18 offset:8192
  v_mfma_f32_32x32x16_bf16 v[208:223], a[248:251], v[112:115], v[208:223]
  v_mfma_f32_16x16x32_bf16 v[244:247], v[240:243], v[112:115], v[244:247]
  v_exp_f32 v35, v35
  ds_read_b128 a[204:207], v19 offset:8192
  v_mfma_f32_32x32x16_bf16 v[160:175], a[228:231], v[116:119], v[160:175]
  v_exp_f32 v36, v36
  v_cvt_pk_bf16_f32 v97, v34, v35
  ds_read_b128 a[208:211], v20 offset:8192
  v_mfma_f32_32x32x16_bf16 v[176:191], a[236:239], v[116:119], v[176:191]
  v_exp_f32 v37, v37
  ds_read_b128 a[212:215], v21 offset:8192
  v_mfma_f32_32x32x16_bf16 v[192:207], a[244:247], v[116:119], v[192:207]
  v_exp_f32 v38, v38
  v_cvt_pk_bf16_f32 v98, v36, v37
  ds_read_b128 a[216:219], v22 offset:8192
  v_mfma_f32_32x32x16_bf16 v[208:223], a[252:255], v[116:119], v[208:223]
  v_mfma_f32_16x16x32_bf16 v[244:247], v[240:243], v[116:119], v[244:247]
  v_exp_f32 v39, v39
  ds_read_b128 a[220:223], v23 offset:8192
  v_mfma_f32_32x32x16_bf16 a[0:15], a[224:227], v[120:123], a[0:15]
  v_exp_f32 v40, v40
  v_cvt_pk_bf16_f32 v99, v38, v39
  s_add_u32 m0, s12, 40960
  s_mov_b32 s13, 106496
  v_mfma_f32_32x32x16_bf16 a[16:31], a[232:235], v[120:123], a[16:31]
  v_exp_f32 v41, v41
  buffer_load_dwordx4 v10, s[32:35], s13 offen offset:0 nt lds
  buffer_load_dwordx4 v11, s[32:35], s13 offen offset:1024 nt lds
  s_add_u32 m0, s12, 90112
  v_mfma_f32_32x32x16_bf16 a[32:47], a[240:243], v[120:123], a[32:47]
  v_exp_f32 v42, v42
  v_cvt_pk_bf16_f32 v100, v40, v41
  s_mov_b32 s13, 90112
  buffer_load_dwordx4 v12, s[36:39], s13 offen offset:0 nt lds
  v_mfma_f32_32x32x16_bf16 a[48:63], a[248:251], v[120:123], a[48:63]
  v_mfma_f32_16x16x32_bf16 v[248:251], v[240:243], v[120:123], v[248:251]
  v_exp_f32 v43, v43
  buffer_load_dwordx4 v12, s[36:39], s13 offen offset:1024 nt lds
  s_add_u32 m0, s12, 0
  s_add_u32 s13, s71, 0
  v_mfma_f32_32x32x16_bf16 a[0:15], a[228:231], v[124:127], a[0:15]
  v_exp_f32 v44, v44
  v_cvt_pk_bf16_f32 v101, v42, v43
  buffer_load_dwordx4 v13, s[48:51], s13 offen lds
  s_add_u32 m0, s12, 1024
  s_add_u32 s13, s71, 4096
  v_mfma_f32_32x32x16_bf16 a[16:31], a[236:239], v[124:127], a[16:31]
  v_exp_f32 v45, v45
  buffer_load_dwordx4 v13, s[48:51], s13 offen lds
  buffer_load_dword v252, v235, s[52:55], s78 offen
  v_mfma_f32_32x32x16_bf16 a[32:47], a[244:247], v[124:127], a[32:47]
  v_exp_f32 v46, v46
  v_cvt_pk_bf16_f32 v102, v44, v45
  s_lshl_b32 s13, s11, 9
  s_add_u32 s13, s13, 34619392
  buffer_load_dword v253, v235, s[52:55], s13 offen
  v_mfma_f32_32x32x16_bf16 a[48:63], a[252:255], v[124:127], a[48:63]
  v_mfma_f32_16x16x32_bf16 v[248:251], v[240:243], v[124:127], v[248:251]
  v_exp_f32 v47, v47
  s_lshl_b32 s13, s11, 7
  s_add_u32 s13, s13, 34668544
  buffer_load_dword v254, v15, s[52:55], s13 offen
  s_nop 0
  v_cvt_pk_bf16_f32 v103, v46, v47
  s_waitcnt lgkmcnt(0)
  v_mfma_f32_32x32x16_bf16 v[64:79], a[192:195], a[128:131], v[128:143]
  s_waitcnt vmcnt(17) lgkmcnt(0)
  s_barrier
  v_exp_f32 v48, v48
  v_mfma_f32_32x32x16_bf16 v[64:79], a[196:199], a[132:135], v[64:79]
  v_exp_f32 v49, v49
  ds_read_b64_tr_b16 a[224:225], v24 offset:0
  v_mfma_f32_32x32x16_bf16 v[64:79], a[200:203], a[136:139], v[64:79]
  v_exp_f32 v50, v50
  v_cvt_pk_bf16_f32 v104, v48, v49
  ds_read_b64_tr_b16 a[226:227], v24 offset:2048
  v_mfma_f32_32x32x16_bf16 v[64:79], a[204:207], a[140:143], v[64:79]
  v_exp_f32 v51, v51
  ds_read_b64_tr_b16 a[232:233], v25 offset:0
  ds_read_b64_tr_b16 a[234:235], v25 offset:2048
  v_mfma_f32_32x32x16_bf16 v[64:79], a[208:211], a[144:147], v[64:79]
  v_exp_f32 v52, v52
  v_cvt_pk_bf16_f32 v105, v50, v51
  ds_read_b64_tr_b16 a[240:241], v26 offset:0
  v_mfma_f32_32x32x16_bf16 v[64:79], a[212:215], a[148:151], v[64:79]
  v_exp_f32 v53, v53
  ds_read_b64_tr_b16 a[242:243], v26 offset:2048
  ds_read_b64_tr_b16 a[248:249], v27 offset:0
  v_mfma_f32_32x32x16_bf16 v[64:79], a[216:219], a[152:155], v[64:79]
  v_exp_f32 v54, v54
  v_cvt_pk_bf16_f32 v106, v52, v53
  ds_read_b64_tr_b16 a[250:251], v27 offset:2048
  v_mfma_f32_32x32x16_bf16 v[64:79], a[220:223], a[156:159], v[64:79]
  v_exp_f32 v55, v55
  ds_read_b64_tr_b16 a[228:229], v24 offset:4096
  ds_read_b64_tr_b16 a[230:231], v24 offset:6144
  v_mfma_f32_32x32x16_bf16 v[80:95], a[192:195], a[160:163], v[144:159]
  v_exp_f32 v56, v56
  v_cvt_pk_bf16_f32 v107, v54, v55
  ds_read_b64_tr_b16 a[236:237], v25 offset:4096
  v_mfma_f32_32x32x16_bf16 v[80:95], a[196:199], a[164:167], v[80:95]
  v_exp_f32 v57, v57
  ds_read_b64_tr_b16 a[238:239], v25 offset:6144
  ds_read_b64_tr_b16 a[244:245], v26 offset:4096
  v_mfma_f32_32x32x16_bf16 v[80:95], a[200:203], a[168:171], v[80:95]
  v_exp_f32 v58, v58
  v_cvt_pk_bf16_f32 v108, v56, v57
  ds_read_b64_tr_b16 a[246:247], v26 offset:6144
  v_mfma_f32_32x32x16_bf16 v[80:95], a[204:207], a[172:175], v[80:95]
  v_exp_f32 v59, v59
  ds_read_b64_tr_b16 a[252:253], v27 offset:4096
  ds_read_b64_tr_b16 a[254:255], v27 offset:6144
  v_mfma_f32_32x32x16_bf16 v[80:95], a[208:211], a[176:179], v[80:95]
  v_exp_f32 v60, v60
  v_cvt_pk_bf16_f32 v109, v58, v59
  v_mfma_f32_32x32x16_bf16 v[80:95], a[212:215], a[180:183], v[80:95]
  v_exp_f32 v61, v61
  v_mfma_f32_32x32x16_bf16 v[80:95], a[216:219], a[184:187], v[80:95]
  v_exp_f32 v62, v62
  v_cvt_pk_bf16_f32 v110, v60, v61
  v_mfma_f32_32x32x16_bf16 v[80:95], a[220:223], a[188:191], v[80:95]
  v_exp_f32 v63, v63
  s_nop 0
  v_cvt_pk_bf16_f32 v111, v62, v63
  s_waitcnt lgkmcnt(0)
  v_mfma_f32_32x32x16_bf16 v[160:175], a[224:227], v[96:99], v[160:175]
  v_exp_f32 v64, v64
  ds_read_b128 a[192:195], v16 offset:16384
  v_mfma_f32_32x32x16_bf16 v[176:191], a[232:235], v[96:99], v[176:191]
  v_exp_f32 v65, v65
  ds_read_b128 a[196:199], v17 offset:16384
  v_mfma_f32_32x32x16_bf16 v[192:207], a[240:243], v[96:99], v[192:207]
  v_exp_f32 v66, v66
  v_cvt_pk_bf16_f32 v112, v64, v65
  ds_read_b128 a[200:203], v18 offset:16384
  v_mfma_f32_32x32x16_bf16 v[208:223], a[248:251], v[96:99], v[208:223]
  v_mfma_f32_16x16x32_bf16 v[244:247], v[240:243], v[96:99], v[244:247]
  v_exp_f32 v67, v67
  ds_read_b128 a[204:207], v19 offset:16384
  v_mfma_f32_32x32x16_bf16 v[160:175], a[228:231], v[100:103], v[160:175]
  v_exp_f32 v68, v68
  v_cvt_pk_bf16_f32 v113, v66, v67
  ds_read_b128 a[208:211], v20 offset:16384
  v_mfma_f32_32x32x16_bf16 v[176:191], a[236:239], v[100:103], v[176:191]
  v_exp_f32 v69, v69
  ds_read_b128 a[212:215], v21 offset:16384
  v_mfma_f32_32x32x16_bf16 v[192:207], a[244:247], v[100:103], v[192:207]
  v_exp_f32 v70, v70
  v_cvt_pk_bf16_f32 v114, v68, v69
  ds_read_b128 a[216:219], v22 offset:16384
  v_mfma_f32_32x32x16_bf16 v[208:223], a[252:255], v[100:103], v[208:223]
  v_mfma_f32_16x16x32_bf16 v[244:247], v[240:243], v[100:103], v[244:247]
  v_exp_f32 v71, v71
  ds_read_b128 a[220:223], v23 offset:16384
  v_mfma_f32_32x32x16_bf16 a[0:15], a[224:227], v[104:107], a[0:15]
  v_exp_f32 v72, v72
  v_cvt_pk_bf16_f32 v115, v70, v71
  s_add_u32 m0, s12, 49152
  s_mov_b32 s13, 114688
  v_mfma_f32_32x32x16_bf16 a[16:31], a[232:235], v[104:107], a[16:31]
  v_exp_f32 v73, v73
  buffer_load_dwordx4 v10, s[32:35], s13 offen offset:0 nt lds
  buffer_load_dwordx4 v11, s[32:35], s13 offen offset:1024 nt lds
  v_mfma_f32_32x32x16_bf16 a[32:47], a[240:243], v[104:107], a[32:47]
  v_exp_f32 v74, v74
  v_cvt_pk_bf16_f32 v116, v72, v73
  s_add_u32 m0, s12, 98304
  s_mov_b32 s13, 98304
  v_mfma_f32_32x32x16_bf16 a[48:63], a[248:251], v[104:107], a[48:63]
  v_mfma_f32_16x16x32_bf16 v[248:251], v[240:243], v[104:107], v[248:251]
  v_exp_f32 v75, v75
  buffer_load_dwordx4 v12, s[36:39], s13 offen offset:0 nt lds
  buffer_load_dwordx4 v12, s[36:39], s13 offen offset:1024 nt lds
  v_mfma_f32_32x32x16_bf16 a[0:15], a[228:231], v[108:111], a[0:15]
  v_exp_f32 v76, v76
  v_cvt_pk_bf16_f32 v117, v74, v75
  s_add_u32 m0, s12, 8192
  s_add_u32 s13, s71, 32768
  v_mfma_f32_32x32x16_bf16 a[16:31], a[236:239], v[108:111], a[16:31]
  v_exp_f32 v77, v77
  buffer_load_dwordx4 v13, s[48:51], s13 offen lds
  s_add_u32 m0, s12, 9216
  v_mfma_f32_32x32x16_bf16 a[32:47], a[244:247], v[108:111], a[32:47]
  v_exp_f32 v78, v78
  v_cvt_pk_bf16_f32 v118, v76, v77
  s_add_u32 s13, s71, 36864
  buffer_load_dwordx4 v13, s[48:51], s13 offen lds
  v_mfma_f32_32x32x16_bf16 a[48:63], a[252:255], v[108:111], a[48:63]
  v_mfma_f32_16x16x32_bf16 v[248:251], v[240:243], v[108:111], v[248:251]
  v_exp_f32 v79, v79
  s_add_u32 s13, s77, 0
  buffer_load_dword v255, v236, s[52:55], s13 offen
  s_nop 0
  v_cvt_pk_bf16_f32 v119, v78, v79
  s_waitcnt lgkmcnt(0)
  v_mfma_f32_32x32x16_bf16 v[32:47], a[192:195], a[128:131], v[128:143]
  s_waitcnt vmcnt(20) lgkmcnt(0)
  s_barrier
  v_exp_f32 v80, v80
  v_mfma_f32_32x32x16_bf16 v[32:47], a[196:199], a[132:135], v[32:47]
  v_exp_f32 v81, v81
  ds_read_b64_tr_b16 a[224:225], v24 offset:8192
  v_mfma_f32_32x32x16_bf16 v[32:47], a[200:203], a[136:139], v[32:47]
  v_exp_f32 v82, v82
  v_cvt_pk_bf16_f32 v120, v80, v81
  ds_read_b64_tr_b16 a[226:227], v24 offset:10240
  v_mfma_f32_32x32x16_bf16 v[32:47], a[204:207], a[140:143], v[32:47]
  v_exp_f32 v83, v83
  ds_read_b64_tr_b16 a[232:233], v25 offset:8192
  ds_read_b64_tr_b16 a[234:235], v25 offset:10240
  v_mfma_f32_32x32x16_bf16 v[32:47], a[208:211], a[144:147], v[32:47]
  v_exp_f32 v84, v84
  v_cvt_pk_bf16_f32 v121, v82, v83
  ds_read_b64_tr_b16 a[240:241], v26 offset:8192
  v_mfma_f32_32x32x16_bf16 v[32:47], a[212:215], a[148:151], v[32:47]
  v_exp_f32 v85, v85
  ds_read_b64_tr_b16 a[242:243], v26 offset:10240
  ds_read_b64_tr_b16 a[248:249], v27 offset:8192
  v_mfma_f32_32x32x16_bf16 v[32:47], a[216:219], a[152:155], v[32:47]
  v_exp_f32 v86, v86
  v_cvt_pk_bf16_f32 v122, v84, v85
  ds_read_b64_tr_b16 a[250:251], v27 offset:10240
  v_mfma_f32_32x32x16_bf16 v[32:47], a[220:223], a[156:159], v[32:47]
  v_exp_f32 v87, v87
  ds_read_b64_tr_b16 a[228:229], v24 offset:12288
  ds_read_b64_tr_b16 a[230:231], v24 offset:14336
  v_mfma_f32_32x32x16_bf16 v[48:63], a[192:195], a[160:163], v[144:159]
  v_exp_f32 v88, v88
  v_cvt_pk_bf16_f32 v123, v86, v87
  ds_read_b64_tr_b16 a[236:237], v25 offset:12288
  v_mfma_f32_32x32x16_bf16 v[48:63], a[196:199], a[164:167], v[48:63]
  v_exp_f32 v89, v89
  ds_read_b64_tr_b16 a[238:239], v25 offset:14336
  ds_read_b64_tr_b16 a[244:245], v26 offset:12288
  v_mfma_f32_32x32x16_bf16 v[48:63], a[200:203], a[168:171], v[48:63]
  v_exp_f32 v90, v90
  v_cvt_pk_bf16_f32 v124, v88, v89
  ds_read_b64_tr_b16 a[246:247], v26 offset:14336
  v_mfma_f32_32x32x16_bf16 v[48:63], a[204:207], a[172:175], v[48:63]
  v_exp_f32 v91, v91
  ds_read_b64_tr_b16 a[252:253], v27 offset:12288
  ds_read_b64_tr_b16 a[254:255], v27 offset:14336
  v_mfma_f32_32x32x16_bf16 v[48:63], a[208:211], a[176:179], v[48:63]
  v_exp_f32 v92, v92
  v_cvt_pk_bf16_f32 v125, v90, v91
  v_mfma_f32_32x32x16_bf16 v[48:63], a[212:215], a[180:183], v[48:63]
  v_exp_f32 v93, v93
  v_mfma_f32_32x32x16_bf16 v[48:63], a[216:219], a[184:187], v[48:63]
  v_exp_f32 v94, v94
  v_cvt_pk_bf16_f32 v126, v92, v93
  v_mfma_f32_32x32x16_bf16 v[48:63], a[220:223], a[188:191], v[48:63]
  v_exp_f32 v95, v95
  s_nop 0
  v_cvt_pk_bf16_f32 v127, v94, v95
  s_waitcnt lgkmcnt(0)
  v_mfma_f32_32x32x16_bf16 v[160:175], a[224:227], v[112:115], v[160:175]
  v_exp_f32 v32, v32
  ds_read_b128 a[192:195], v16 offset:24576
  v_mfma_f32_32x32x16_bf16 v[176:191], a[232:235], v[112:115], v[176:191]
  v_exp_f32 v33, v33
  ds_read_b128 a[196:199], v17 offset:24576
  v_mfma_f32_32x32x16_bf16 v[192:207], a[240:243], v[112:115], v[192:207]
  v_exp_f32 v34, v34
  v_cvt_pk_bf16_f32 v96, v32, v33
  ds_read_b128 a[200:203], v18 offset:24576
  v_mfma_f32_32x32x16_bf16 v[208:223], a[248:251], v[112:115], v[208:223]
  v_mfma_f32_16x16x32_bf16 v[244:247], v[240:243], v[112:115], v[244:247]
  v_exp_f32 v35, v35
  ds_read_b128 a[204:207], v19 offset:24576
  v_mfma_f32_32x32x16_bf16 v[160:175], a[228:231], v[116:119], v[160:175]
  v_exp_f32 v36, v36
  v_cvt_pk_bf16_f32 v97, v34, v35
  ds_read_b128 a[208:211], v20 offset:24576
  v_mfma_f32_32x32x16_bf16 v[176:191], a[236:239], v[116:119], v[176:191]
  v_exp_f32 v37, v37
  ds_read_b128 a[212:215], v21 offset:24576
  v_mfma_f32_32x32x16_bf16 v[192:207], a[244:247], v[116:119], v[192:207]
  v_exp_f32 v38, v38
  v_cvt_pk_bf16_f32 v98, v36, v37
  ds_read_b128 a[216:219], v22 offset:24576
  v_mfma_f32_32x32x16_bf16 v[208:223], a[252:255], v[116:119], v[208:223]
  v_mfma_f32_16x16x32_bf16 v[244:247], v[240:243], v[116:119], v[244:247]
  v_exp_f32 v39, v39
  ds_read_b128 a[220:223], v23 offset:24576
  v_mfma_f32_32x32x16_bf16 a[0:15], a[224:227], v[120:123], a[0:15]
  v_exp_f32 v40, v40
  v_cvt_pk_bf16_f32 v99, v38, v39
  s_add_u32 m0, s12, 57344
  s_mov_b32 s13, 122880
  v_mfma_f32_32x32x16_bf16 a[16:31], a[232:235], v[120:123], a[16:31]
  v_exp_f32 v41, v41
  buffer_load_dwordx4 v10, s[32:35], s13 offen offset:0 nt lds
  buffer_load_dwordx4 v11, s[32:35], s13 offen offset:1024 nt lds
  v_mfma_f32_32x32x16_bf16 a[32:47], a[240:243], v[120:123], a[32:47]
  v_exp_f32 v42, v42
  v_cvt_pk_bf16_f32 v100, v40, v41
  s_add_u32 m0, s12, 106496
  s_mov_b32 s13, 106496
  v_mfma_f32_32x32x16_bf16 a[48:63], a[248:251], v[120:123], a[48:63]
  v_mfma_f32_16x16x32_bf16 v[248:251], v[240:243], v[120:123], v[248:251]
  v_exp_f32 v43, v43
  buffer_load_dwordx4 v12, s[36:39], s13 offen offset:0 nt lds
  buffer_load_dwordx4 v12, s[36:39], s13 offen offset:1024 nt lds
  v_mfma_f32_32x32x16_bf16 a[0:15], a[228:231], v[124:127], a[0:15]
  v_exp_f32 v44, v44
  v_cvt_pk_bf16_f32 v101, v42, v43
  s_add_u32 m0, s12, 16384
  s_add_u32 s13, s71, 65536
  v_mfma_f32_32x32x16_bf16 a[16:31], a[236:239], v[124:127], a[16:31]
  v_exp_f32 v45, v45
  buffer_load_dwordx4 v13, s[48:51], s13 offen lds
  s_add_u32 m0, s12, 17408
  v_mfma_f32_32x32x16_bf16 a[32:47], a[244:247], v[124:127], a[32:47]
  v_exp_f32 v46, v46
  v_cvt_pk_bf16_f32 v102, v44, v45
  s_add_u32 s13, s71, 69632
  buffer_load_dwordx4 v13, s[48:51], s13 offen lds
  v_mfma_f32_32x32x16_bf16 a[48:63], a[252:255], v[124:127], a[48:63]
  v_mfma_f32_16x16x32_bf16 v[248:251], v[240:243], v[124:127], v[248:251]
  v_exp_f32 v47, v47
  s_add_u32 s13, s77, 2048
  buffer_load_dword v237, v236, s[52:55], s13 offen
  s_nop 0
  v_cvt_pk_bf16_f32 v103, v46, v47
  s_waitcnt lgkmcnt(0)
  v_mfma_f32_32x32x16_bf16 v[64:79], a[192:195], a[128:131], v[128:143]
  s_waitcnt vmcnt(23) lgkmcnt(0)
  s_barrier
  v_exp_f32 v48, v48
  v_mfma_f32_32x32x16_bf16 v[64:79], a[196:199], a[132:135], v[64:79]
  v_exp_f32 v49, v49
  ds_read_b64_tr_b16 a[224:225], v24 offset:16384
  v_mfma_f32_32x32x16_bf16 v[64:79], a[200:203], a[136:139], v[64:79]
  v_exp_f32 v50, v50
  v_cvt_pk_bf16_f32 v104, v48, v49
  ds_read_b64_tr_b16 a[226:227], v24 offset:18432
  v_mfma_f32_32x32x16_bf16 v[64:79], a[204:207], a[140:143], v[64:79]
  v_exp_f32 v51, v51
  ds_read_b64_tr_b16 a[232:233], v25 offset:16384
  ds_read_b64_tr_b16 a[234:235], v25 offset:18432
  v_mfma_f32_32x32x16_bf16 v[64:79], a[208:211], a[144:147], v[64:79]
  v_exp_f32 v52, v52
  v_cvt_pk_bf16_f32 v105, v50, v51
  ds_read_b64_tr_b16 a[240:241], v26 offset:16384
  v_mfma_f32_32x32x16_bf16 v[64:79], a[212:215], a[148:151], v[64:79]
  v_exp_f32 v53, v53
  ds_read_b64_tr_b16 a[242:243], v26 offset:18432
  ds_read_b64_tr_b16 a[248:249], v27 offset:16384
  v_mfma_f32_32x32x16_bf16 v[64:79], a[216:219], a[152:155], v[64:79]
  v_exp_f32 v54, v54
  v_cvt_pk_bf16_f32 v106, v52, v53
  ds_read_b64_tr_b16 a[250:251], v27 offset:18432
  v_mfma_f32_32x32x16_bf16 v[64:79], a[220:223], a[156:159], v[64:79]
  v_exp_f32 v55, v55
  ds_read_b64_tr_b16 a[228:229], v24 offset:20480
  ds_read_b64_tr_b16 a[230:231], v24 offset:22528
  v_mfma_f32_32x32x16_bf16 v[80:95], a[192:195], a[160:163], v[144:159]
  v_exp_f32 v56, v56
  v_cvt_pk_bf16_f32 v107, v54, v55
  ds_read_b64_tr_b16 a[236:237], v25 offset:20480
  v_mfma_f32_32x32x16_bf16 v[80:95], a[196:199], a[164:167], v[80:95]
  v_exp_f32 v57, v57
  ds_read_b64_tr_b16 a[238:239], v25 offset:22528
  ds_read_b64_tr_b16 a[244:245], v26 offset:20480
  v_mfma_f32_32x32x16_bf16 v[80:95], a[200:203], a[168:171], v[80:95]
  v_exp_f32 v58, v58
  v_cvt_pk_bf16_f32 v108, v56, v57
  ds_read_b64_tr_b16 a[246:247], v26 offset:22528
  v_mfma_f32_32x32x16_bf16 v[80:95], a[204:207], a[172:175], v[80:95]
  v_exp_f32 v59, v59
  ds_read_b64_tr_b16 a[252:253], v27 offset:20480
  ds_read_b64_tr_b16 a[254:255], v27 offset:22528
  v_mfma_f32_32x32x16_bf16 v[80:95], a[208:211], a[176:179], v[80:95]
  v_exp_f32 v60, v60
  v_cvt_pk_bf16_f32 v109, v58, v59
  v_mfma_f32_32x32x16_bf16 v[80:95], a[212:215], a[180:183], v[80:95]
  v_exp_f32 v61, v61
  v_mfma_f32_32x32x16_bf16 v[80:95], a[216:219], a[184:187], v[80:95]
  v_exp_f32 v62, v62
  v_cvt_pk_bf16_f32 v110, v60, v61
  v_mfma_f32_32x32x16_bf16 v[80:95], a[220:223], a[188:191], v[80:95]
  v_exp_f32 v63, v63
  s_nop 0
  v_cvt_pk_bf16_f32 v111, v62, v63
  s_waitcnt lgkmcnt(0)
  v_mfma_f32_32x32x16_bf16 v[160:175], a[224:227], v[96:99], v[160:175]
  v_exp_f32 v64, v64
  ds_read_b128 a[192:195], v16 offset:32768
  v_mfma_f32_32x32x16_bf16 v[176:191], a[232:235], v[96:99], v[176:191]
  v_exp_f32 v65, v65
  ds_read_b128 a[196:199], v17 offset:32768
  v_mfma_f32_32x32x16_bf16 v[192:207], a[240:243], v[96:99], v[192:207]
  v_exp_f32 v66, v66
  v_cvt_pk_bf16_f32 v112, v64, v65
  ds_read_b128 a[200:203], v18 offset:32768
  v_mfma_f32_32x32x16_bf16 v[208:223], a[248:251], v[96:99], v[208:223]
  v_mfma_f32_16x16x32_bf16 v[244:247], v[240:243], v[96:99], v[244:247]
  v_exp_f32 v67, v67
  ds_read_b128 a[204:207], v19 offset:32768
  v_mfma_f32_32x32x16_bf16 v[160:175], a[228:231], v[100:103], v[160:175]
  v_exp_f32 v68, v68
  v_cvt_pk_bf16_f32 v113, v66, v67
  ds_read_b128 a[208:211], v20 offset:32768
  v_mfma_f32_32x32x16_bf16 v[176:191], a[236:239], v[100:103], v[176:191]
  v_exp_f32 v69, v69
  ds_read_b128 a[212:215], v21 offset:32768
  v_mfma_f32_32x32x16_bf16 v[192:207], a[244:247], v[100:103], v[192:207]
  v_exp_f32 v70, v70
  v_cvt_pk_bf16_f32 v114, v68, v69
  ds_read_b128 a[216:219], v22 offset:32768
  v_mfma_f32_32x32x16_bf16 v[208:223], a[252:255], v[100:103], v[208:223]
  v_mfma_f32_16x16x32_bf16 v[244:247], v[240:243], v[100:103], v[244:247]
  v_exp_f32 v71, v71
  ds_read_b128 a[220:223], v23 offset:32768
  v_mfma_f32_32x32x16_bf16 a[0:15], a[224:227], v[104:107], a[0:15]
  v_exp_f32 v72, v72
  v_cvt_pk_bf16_f32 v115, v70, v71
  s_add_u32 m0, s12, 114688
  s_mov_b32 s13, 114688
  v_mfma_f32_32x32x16_bf16 a[16:31], a[232:235], v[104:107], a[16:31]
  v_exp_f32 v73, v73
  buffer_load_dwordx4 v12, s[36:39], s13 offen offset:0 nt lds
  buffer_load_dwordx4 v12, s[36:39], s13 offen offset:1024 nt lds
  v_mfma_f32_32x32x16_bf16 a[32:47], a[240:243], v[104:107], a[32:47]
  v_exp_f32 v74, v74
  v_cvt_pk_bf16_f32 v116, v72, v73
  s_add_u32 m0, s12, 122880
  s_mov_b32 s13, 122880
  v_mfma_f32_32x32x16_bf16 a[48:63], a[248:251], v[104:107], a[48:63]
  v_mfma_f32_16x16x32_bf16 v[248:251], v[240:243], v[104:107], v[248:251]
  v_exp_f32 v75, v75
  buffer_load_dwordx4 v12, s[36:39], s13 offen offset:0 nt lds
  buffer_load_dwordx4 v12, s[36:39], s13 offen offset:1024 nt lds
  v_mfma_f32_32x32x16_bf16 a[0:15], a[228:231], v[108:111], a[0:15]
  v_exp_f32 v76, v76
  v_cvt_pk_bf16_f32 v117, v74, v75
  s_add_u32 m0, s12, 24576
  s_add_u32 s13, s71, 98304
  v_mfma_f32_32x32x16_bf16 a[16:31], a[236:239], v[108:111], a[16:31]
  v_exp_f32 v77, v77
  buffer_load_dwordx4 v13, s[48:51], s13 offen lds
  s_add_u32 m0, s12, 25600
  v_mfma_f32_32x32x16_bf16 a[32:47], a[244:247], v[108:111], a[32:47]
  v_exp_f32 v78, v78
  v_cvt_pk_bf16_f32 v118, v76, v77
  s_add_u32 s13, s71, 102400
  buffer_load_dwordx4 v13, s[48:51], s13 offen lds
  v_mfma_f32_32x32x16_bf16 a[48:63], a[252:255], v[108:111], a[48:63]
  v_mfma_f32_16x16x32_bf16 v[248:251], v[240:243], v[108:111], v[248:251]
  v_exp_f32 v79, v79
  s_add_u32 s13, s77, 4096
  buffer_load_dword v238, v236, s[52:55], s13 offen
  s_nop 0
  v_cvt_pk_bf16_f32 v119, v78, v79
  s_waitcnt lgkmcnt(0)
  v_mfma_f32_32x32x16_bf16 v[32:47], a[192:195], a[128:131], v[128:143]
  s_waitcnt vmcnt(26) lgkmcnt(0)
  s_barrier
  v_exp_f32 v80, v80
  v_mfma_f32_32x32x16_bf16 v[32:47], a[196:199], a[132:135], v[32:47]
  v_exp_f32 v81, v81
  ds_read_b64_tr_b16 a[224:225], v24 offset:24576
  v_mfma_f32_32x32x16_bf16 v[32:47], a[200:203], a[136:139], v[32:47]
  v_exp_f32 v82, v82
  v_cvt_pk_bf16_f32 v120, v80, v81
  ds_read_b64_tr_b16 a[226:227], v24 offset:26624
  v_mfma_f32_32x32x16_bf16 v[32:47], a[204:207], a[140:143], v[32:47]
  v_exp_f32 v83, v83
  ds_read_b64_tr_b16 a[232:233], v25 offset:24576
  ds_read_b64_tr_b16 a[234:235], v25 offset:26624
  v_mfma_f32_32x32x16_bf16 v[32:47], a[208:211], a[144:147], v[32:47]
  v_exp_f32 v84, v84
  v_cvt_pk_bf16_f32 v121, v82, v83
  ds_read_b64_tr_b16 a[240:241], v26 offset:24576
  v_mfma_f32_32x32x16_bf16 v[32:47], a[212:215], a[148:151], v[32:47]
  v_exp_f32 v85, v85
  ds_read_b64_tr_b16 a[242:243], v26 offset:26624
  ds_read_b64_tr_b16 a[248:249], v27 offset:24576
  v_mfma_f32_32x32x16_bf16 v[32:47], a[216:219], a[152:155], v[32:47]
  v_exp_f32 v86, v86
  v_cvt_pk_bf16_f32 v122, v84, v85
  ds_read_b64_tr_b16 a[250:251], v27 offset:26624
  v_mfma_f32_32x32x16_bf16 v[32:47], a[220:223], a[156:159], v[32:47]
  v_exp_f32 v87, v87
  ds_read_b64_tr_b16 a[228:229], v24 offset:28672
  ds_read_b64_tr_b16 a[230:231], v24 offset:30720
  v_mfma_f32_32x32x16_bf16 v[48:63], a[192:195], a[160:163], v[144:159]
  v_exp_f32 v88, v88
  v_cvt_pk_bf16_f32 v123, v86, v87
  ds_read_b64_tr_b16 a[236:237], v25 offset:28672
  v_mfma_f32_32x32x16_bf16 v[48:63], a[196:199], a[164:167], v[48:63]
  v_exp_f32 v89, v89
  ds_read_b64_tr_b16 a[238:239], v25 offset:30720
  ds_read_b64_tr_b16 a[244:245], v26 offset:28672
  v_mfma_f32_32x32x16_bf16 v[48:63], a[200:203], a[168:171], v[48:63]
  v_exp_f32 v90, v90
  v_cvt_pk_bf16_f32 v124, v88, v89
  ds_read_b64_tr_b16 a[246:247], v26 offset:30720
  v_mfma_f32_32x32x16_bf16 v[48:63], a[204:207], a[172:175], v[48:63]
  v_exp_f32 v91, v91
  ds_read_b64_tr_b16 a[252:253], v27 offset:28672
  ds_read_b64_tr_b16 a[254:255], v27 offset:30720
  v_mfma_f32_32x32x16_bf16 v[48:63], a[208:211], a[176:179], v[48:63]
  v_exp_f32 v92, v92
  v_cvt_pk_bf16_f32 v125, v90, v91
  v_mfma_f32_32x32x16_bf16 v[48:63], a[212:215], a[180:183], v[48:63]
  v_exp_f32 v93, v93
  v_mfma_f32_32x32x16_bf16 v[48:63], a[216:219], a[184:187], v[48:63]
  v_exp_f32 v94, v94
  v_cvt_pk_bf16_f32 v126, v92, v93
  v_mfma_f32_32x32x16_bf16 v[48:63], a[220:223], a[188:191], v[48:63]
  v_exp_f32 v95, v95
  s_nop 0
  v_cvt_pk_bf16_f32 v127, v94, v95
  s_waitcnt lgkmcnt(0)
  v_mfma_f32_32x32x16_bf16 v[160:175], a[224:227], v[112:115], v[160:175]
  v_exp_f32 v32, v32
  ds_read_b128 a[192:195], v16 offset:40960
  v_mfma_f32_32x32x16_bf16 v[176:191], a[232:235], v[112:115], v[176:191]
  v_exp_f32 v33, v33
  ds_read_b128 a[196:199], v17 offset:40960
  v_mfma_f32_32x32x16_bf16 v[192:207], a[240:243], v[112:115], v[192:207]
  v_exp_f32 v34, v34
  v_cvt_pk_bf16_f32 v96, v32, v33
  ds_read_b128 a[200:203], v18 offset:40960
  v_mfma_f32_32x32x16_bf16 v[208:223], a[248:251], v[112:115], v[208:223]
  v_mfma_f32_16x16x32_bf16 v[244:247], v[240:243], v[112:115], v[244:247]
  v_exp_f32 v35, v35
  ds_read_b128 a[204:207], v19 offset:40960
  v_mfma_f32_32x32x16_bf16 v[160:175], a[228:231], v[116:119], v[160:175]
  v_exp_f32 v36, v36
  v_cvt_pk_bf16_f32 v97, v34, v35
  ds_read_b128 a[208:211], v20 offset:40960
  v_mfma_f32_32x32x16_bf16 v[176:191], a[236:239], v[116:119], v[176:191]
  v_exp_f32 v37, v37
  ds_read_b128 a[212:215], v21 offset:40960
  v_mfma_f32_32x32x16_bf16 v[192:207], a[244:247], v[116:119], v[192:207]
  v_exp_f32 v38, v38
  v_cvt_pk_bf16_f32 v98, v36, v37
  ds_read_b128 a[216:219], v22 offset:40960
  v_mfma_f32_32x32x16_bf16 v[208:223], a[252:255], v[116:119], v[208:223]
  v_mfma_f32_16x16x32_bf16 v[244:247], v[240:243], v[116:119], v[244:247]
  v_exp_f32 v39, v39
  ds_read_b128 a[220:223], v23 offset:40960
  v_mfma_f32_32x32x16_bf16 a[0:15], a[224:227], v[120:123], a[0:15]
  v_exp_f32 v40, v40
  v_cvt_pk_bf16_f32 v99, v38, v39
  s_add_u32 m0, s12, 32768
  v_mfma_f32_32x32x16_bf16 a[16:31], a[232:235], v[120:123], a[16:31]
  v_exp_f32 v41, v41
  s_add_u32 s13, s72, 0
  buffer_load_dwordx4 v13, s[48:51], s13 offen lds
  v_mfma_f32_32x32x16_bf16 a[32:47], a[240:243], v[120:123], a[32:47]
  v_exp_f32 v42, v42
  v_cvt_pk_bf16_f32 v100, v40, v41
  s_add_u32 m0, s12, 33792
  s_add_u32 s13, s72, 4096
  v_mfma_f32_32x32x16_bf16 a[48:63], a[248:251], v[120:123], a[48:63]
  v_mfma_f32_16x16x32_bf16 v[248:251], v[240:243], v[120:123], v[248:251]
  v_exp_f32 v43, v43
  buffer_load_dwordx4 v13, s[48:51], s13 offen lds
  s_add_u32 m0, s12, 65536
  v_mfma_f32_32x32x16_bf16 a[0:15], a[228:231], v[124:127], a[0:15]
  v_exp_f32 v44, v44
  v_cvt_pk_bf16_f32 v101, v42, v43
  s_add_u32 s13, s73, 0
  v_mfma_f32_32x32x16_bf16 a[16:31], a[236:239], v[124:127], a[16:31]
  v_exp_f32 v45, v45
  buffer_load_dwordx4 v13, s[48:51], s13 offen lds
  s_add_u32 m0, s12, 66560
  v_mfma_f32_32x32x16_bf16 a[32:47], a[244:247], v[124:127], a[32:47]
  v_exp_f32 v46, v46
  v_cvt_pk_bf16_f32 v102, v44, v45
  s_add_u32 s13, s73, 4096
  buffer_load_dwordx4 v13, s[48:51], s13 offen lds
  v_mfma_f32_32x32x16_bf16 a[48:63], a[252:255], v[124:127], a[48:63]
  v_mfma_f32_16x16x32_bf16 v[248:251], v[240:243], v[124:127], v[248:251]
  v_exp_f32 v47, v47
  s_add_u32 s13, s77, 6144
  buffer_load_dword v239, v236, s[52:55], s13 offen
  s_nop 0
  v_cvt_pk_bf16_f32 v103, v46, v47
  s_waitcnt lgkmcnt(0)
  v_mfma_f32_32x32x16_bf16 v[64:79], a[192:195], a[128:131], v[128:143]
  s_waitcnt vmcnt(22) lgkmcnt(0)
  s_barrier
  v_exp_f32 v48, v48
  v_mfma_f32_32x32x16_bf16 v[64:79], a[196:199], a[132:135], v[64:79]
  v_exp_f32 v49, v49
  ds_read_b64_tr_b16 a[224:225], v24 offset:32768
  v_mfma_f32_32x32x16_bf16 v[64:79], a[200:203], a[136:139], v[64:79]
  v_exp_f32 v50, v50
  v_cvt_pk_bf16_f32 v104, v48, v49
  ds_read_b64_tr_b16 a[226:227], v24 offset:34816
  v_mfma_f32_32x32x16_bf16 v[64:79], a[204:207], a[140:143], v[64:79]
  v_exp_f32 v51, v51
  ds_read_b64_tr_b16 a[232:233], v25 offset:32768
  ds_read_b64_tr_b16 a[234:235], v25 offset:34816
  v_mfma_f32_32x32x16_bf16 v[64:79], a[208:211], a[144:147], v[64:79]
  v_exp_f32 v52, v52
  v_cvt_pk_bf16_f32 v105, v50, v51
  ds_read_b64_tr_b16 a[240:241], v26 offset:32768
  v_mfma_f32_32x32x16_bf16 v[64:79], a[212:215], a[148:151], v[64:79]
  v_exp_f32 v53, v53
  ds_read_b64_tr_b16 a[242:243], v26 offset:34816
  ds_read_b64_tr_b16 a[248:249], v27 offset:32768
  v_mfma_f32_32x32x16_bf16 v[64:79], a[216:219], a[152:155], v[64:79]
  v_exp_f32 v54, v54
  v_cvt_pk_bf16_f32 v106, v52, v53
  ds_read_b64_tr_b16 a[250:251], v27 offset:34816
  v_mfma_f32_32x32x16_bf16 v[64:79], a[220:223], a[156:159], v[64:79]
  v_exp_f32 v55, v55
  ds_read_b64_tr_b16 a[228:229], v24 offset:36864
  ds_read_b64_tr_b16 a[230:231], v24 offset:38912
  v_mfma_f32_32x32x16_bf16 v[80:95], a[192:195], a[160:163], v[144:159]
  v_exp_f32 v56, v56
  v_cvt_pk_bf16_f32 v107, v54, v55
  ds_read_b64_tr_b16 a[236:237], v25 offset:36864
  v_mfma_f32_32x32x16_bf16 v[80:95], a[196:199], a[164:167], v[80:95]
  v_exp_f32 v57, v57
  ds_read_b64_tr_b16 a[238:239], v25 offset:38912
  ds_read_b64_tr_b16 a[244:245], v26 offset:36864
  v_mfma_f32_32x32x16_bf16 v[80:95], a[200:203], a[168:171], v[80:95]
  v_exp_f32 v58, v58
  v_cvt_pk_bf16_f32 v108, v56, v57
  ds_read_b64_tr_b16 a[246:247], v26 offset:38912
  v_mfma_f32_32x32x16_bf16 v[80:95], a[204:207], a[172:175], v[80:95]
  v_exp_f32 v59, v59
  ds_read_b64_tr_b16 a[252:253], v27 offset:36864
  ds_read_b64_tr_b16 a[254:255], v27 offset:38912
  v_mfma_f32_32x32x16_bf16 v[80:95], a[208:211], a[176:179], v[80:95]
  v_exp_f32 v60, v60
  v_cvt_pk_bf16_f32 v109, v58, v59
  v_mfma_f32_32x32x16_bf16 v[80:95], a[212:215], a[180:183], v[80:95]
  v_exp_f32 v61, v61
  v_mfma_f32_32x32x16_bf16 v[80:95], a[216:219], a[184:187], v[80:95]
  v_exp_f32 v62, v62
  v_cvt_pk_bf16_f32 v110, v60, v61
  v_mfma_f32_32x32x16_bf16 v[80:95], a[220:223], a[188:191], v[80:95]
  v_exp_f32 v63, v63
  s_nop 0
  v_cvt_pk_bf16_f32 v111, v62, v63
  s_waitcnt lgkmcnt(0)
  v_mfma_f32_32x32x16_bf16 v[160:175], a[224:227], v[96:99], v[160:175]
  v_exp_f32 v64, v64
  ds_read_b128 a[192:195], v16 offset:49152
  v_mfma_f32_32x32x16_bf16 v[176:191], a[232:235], v[96:99], v[176:191]
  v_exp_f32 v65, v65
  ds_read_b128 a[196:199], v17 offset:49152
  v_mfma_f32_32x32x16_bf16 v[192:207], a[240:243], v[96:99], v[192:207]
  v_exp_f32 v66, v66
  v_cvt_pk_bf16_f32 v112, v64, v65
  ds_read_b128 a[200:203], v18 offset:49152
  v_mfma_f32_32x32x16_bf16 v[208:223], a[248:251], v[96:99], v[208:223]
  v_mfma_f32_16x16x32_bf16 v[244:247], v[240:243], v[96:99], v[244:247]
  v_exp_f32 v67, v67
  ds_read_b128 a[204:207], v19 offset:49152
  v_mfma_f32_32x32x16_bf16 v[160:175], a[228:231], v[100:103], v[160:175]
  v_exp_f32 v68, v68
  v_cvt_pk_bf16_f32 v113, v66, v67
  ds_read_b128 a[208:211], v20 offset:49152
  v_mfma_f32_32x32x16_bf16 v[176:191], a[236:239], v[100:103], v[176:191]
  v_exp_f32 v69, v69
  ds_read_b128 a[212:215], v21 offset:49152
  v_mfma_f32_32x32x16_bf16 v[192:207], a[244:247], v[100:103], v[192:207]
  v_exp_f32 v70, v70
  v_cvt_pk_bf16_f32 v114, v68, v69
  ds_read_b128 a[216:219], v22 offset:49152
  v_mfma_f32_32x32x16_bf16 v[208:223], a[252:255], v[100:103], v[208:223]
  v_mfma_f32_16x16x32_bf16 v[244:247], v[240:243], v[100:103], v[244:247]
  v_exp_f32 v71, v71
  ds_read_b128 a[220:223], v23 offset:49152
  v_mfma_f32_32x32x16_bf16 a[0:15], a[224:227], v[104:107], a[0:15]
  v_exp_f32 v72, v72
  v_cvt_pk_bf16_f32 v115, v70, v71
  s_add_u32 m0, s12, 40960
  v_mfma_f32_32x32x16_bf16 a[16:31], a[232:235], v[104:107], a[16:31]
  v_exp_f32 v73, v73
  s_add_u32 s13, s72, 32768
  buffer_load_dwordx4 v13, s[48:51], s13 offen lds
  v_mfma_f32_32x32x16_bf16 a[32:47], a[240:243], v[104:107], a[32:47]
  v_exp_f32 v74, v74
  v_cvt_pk_bf16_f32 v116, v72, v73
  s_add_u32 m0, s12, 41984
  s_add_u32 s13, s72, 36864
  v_mfma_f32_32x32x16_bf16 a[48:63], a[248:251], v[104:107], a[48:63]
  v_mfma_f32_16x16x32_bf16 v[248:251], v[240:243], v[104:107], v[248:251]
  v_exp_f32 v75, v75
  buffer_load_dwordx4 v13, s[48:51], s13 offen lds
  s_add_u32 m0, s12, 73728
  v_mfma_f32_32x32x16_bf16 a[0:15], a[228:231], v[108:111], a[0:15]
  v_exp_f32 v76, v76
  v_cvt_pk_bf16_f32 v117, v74, v75
  s_add_u32 s13, s73, 32768
  v_mfma_f32_32x32x16_bf16 a[16:31], a[236:239], v[108:111], a[16:31]
  v_exp_f32 v77, v77
  buffer_load_dwordx4 v13, s[48:51], s13 offen lds
  s_add_u32 m0, s12, 74752
  v_mfma_f32_32x32x16_bf16 a[32:47], a[244:247], v[108:111], a[32:47]
  v_exp_f32 v78, v78
  v_cvt_pk_bf16_f32 v118, v76, v77
  s_add_u32 s13, s73, 36864
  buffer_load_dwordx4 v13, s[48:51], s13 offen lds
  v_mfma_f32_32x32x16_bf16 a[48:63], a[252:255], v[108:111], a[48:63]
  v_mfma_f32_16x16x32_bf16 v[248:251], v[240:243], v[108:111], v[248:251]
  v_exp_f32 v79, v79
  s_add_u32 s13, s77, 8192
  buffer_load_dword v9, v236, s[52:55], s13 offen
  s_nop 0
  v_cvt_pk_bf16_f32 v119, v78, v79
  s_waitcnt lgkmcnt(0)
  v_mfma_f32_32x32x16_bf16 v[32:47], a[192:195], a[128:131], v[128:143]
  s_waitcnt vmcnt(20) lgkmcnt(0)
  s_barrier
  v_exp_f32 v80, v80
  v_mfma_f32_32x32x16_bf16 v[32:47], a[196:199], a[132:135], v[32:47]
  v_exp_f32 v81, v81
  ds_read_b64_tr_b16 a[224:225], v24 offset:40960
  v_mfma_f32_32x32x16_bf16 v[32:47], a[200:203], a[136:139], v[32:47]
  v_exp_f32 v82, v82
  v_cvt_pk_bf16_f32 v120, v80, v81
  ds_read_b64_tr_b16 a[226:227], v24 offset:43008
  v_mfma_f32_32x32x16_bf16 v[32:47], a[204:207], a[140:143], v[32:47]
  v_exp_f32 v83, v83
  ds_read_b64_tr_b16 a[232:233], v25 offset:40960
  ds_read_b64_tr_b16 a[234:235], v25 offset:43008
  v_mfma_f32_32x32x16_bf16 v[32:47], a[208:211], a[144:147], v[32:47]
  v_exp_f32 v84, v84
  v_cvt_pk_bf16_f32 v121, v82, v83
  ds_read_b64_tr_b16 a[240:241], v26 offset:40960
  v_mfma_f32_32x32x16_bf16 v[32:47], a[212:215], a[148:151], v[32:47]
  v_exp_f32 v85, v85
  ds_read_b64_tr_b16 a[242:243], v26 offset:43008
  ds_read_b64_tr_b16 a[248:249], v27 offset:40960
  v_mfma_f32_32x32x16_bf16 v[32:47], a[216:219], a[152:155], v[32:47]
  v_exp_f32 v86, v86
  v_cvt_pk_bf16_f32 v122, v84, v85
  ds_read_b64_tr_b16 a[250:251], v27 offset:43008
  v_mfma_f32_32x32x16_bf16 v[32:47], a[220:223], a[156:159], v[32:47]
  v_exp_f32 v87, v87
  ds_read_b64_tr_b16 a[228:229], v24 offset:45056
  ds_read_b64_tr_b16 a[230:231], v24 offset:47104
  v_mfma_f32_32x32x16_bf16 v[48:63], a[192:195], a[160:163], v[144:159]
  v_exp_f32 v88, v88
  v_cvt_pk_bf16_f32 v123, v86, v87
  ds_read_b64_tr_b16 a[236:237], v25 offset:45056
  v_mfma_f32_32x32x16_bf16 v[48:63], a[196:199], a[164:167], v[48:63]
  v_exp_f32 v89, v89
  ds_read_b64_tr_b16 a[238:239], v25 offset:47104
  ds_read_b64_tr_b16 a[244:245], v26 offset:45056
  v_mfma_f32_32x32x16_bf16 v[48:63], a[200:203], a[168:171], v[48:63]
  v_exp_f32 v90, v90
  v_cvt_pk_bf16_f32 v124, v88, v89
  ds_read_b64_tr_b16 a[246:247], v26 offset:47104
  v_mfma_f32_32x32x16_bf16 v[48:63], a[204:207], a[172:175], v[48:63]
  v_exp_f32 v91, v91
  ds_read_b64_tr_b16 a[252:253], v27 offset:45056
  ds_read_b64_tr_b16 a[254:255], v27 offset:47104
  v_mfma_f32_32x32x16_bf16 v[48:63], a[208:211], a[176:179], v[48:63]
  v_exp_f32 v92, v92
  v_cvt_pk_bf16_f32 v125, v90, v91
  v_mfma_f32_32x32x16_bf16 v[48:63], a[212:215], a[180:183], v[48:63]
  v_exp_f32 v93, v93
  v_mfma_f32_32x32x16_bf16 v[48:63], a[216:219], a[184:187], v[48:63]
  v_exp_f32 v94, v94
  v_cvt_pk_bf16_f32 v126, v92, v93
  v_mfma_f32_32x32x16_bf16 v[48:63], a[220:223], a[188:191], v[48:63]
  v_exp_f32 v95, v95
  s_nop 0
  v_cvt_pk_bf16_f32 v127, v94, v95
  s_waitcnt lgkmcnt(0)
  v_mfma_f32_32x32x16_bf16 v[160:175], a[224:227], v[112:115], v[160:175]
  v_exp_f32 v32, v32
  ds_read_b128 a[192:195], v16 offset:57344
  v_mfma_f32_32x32x16_bf16 v[176:191], a[232:235], v[112:115], v[176:191]
  v_exp_f32 v33, v33
  ds_read_b128 a[196:199], v17 offset:57344
  v_mfma_f32_32x32x16_bf16 v[192:207], a[240:243], v[112:115], v[192:207]
  v_exp_f32 v34, v34
  v_cvt_pk_bf16_f32 v96, v32, v33
  ds_read_b128 a[200:203], v18 offset:57344
  v_mfma_f32_32x32x16_bf16 v[208:223], a[248:251], v[112:115], v[208:223]
  v_mfma_f32_16x16x32_bf16 v[244:247], v[240:243], v[112:115], v[244:247]
  v_exp_f32 v35, v35
  ds_read_b128 a[204:207], v19 offset:57344
  v_mfma_f32_32x32x16_bf16 v[160:175], a[228:231], v[116:119], v[160:175]
  v_exp_f32 v36, v36
  v_cvt_pk_bf16_f32 v97, v34, v35
  ds_read_b128 a[208:211], v20 offset:57344
  v_mfma_f32_32x32x16_bf16 v[176:191], a[236:239], v[116:119], v[176:191]
  v_exp_f32 v37, v37
  ds_read_b128 a[212:215], v21 offset:57344
  v_mfma_f32_32x32x16_bf16 v[192:207], a[244:247], v[116:119], v[192:207]
  v_exp_f32 v38, v38
  v_cvt_pk_bf16_f32 v98, v36, v37
  ds_read_b128 a[216:219], v22 offset:57344
  v_mfma_f32_32x32x16_bf16 v[208:223], a[252:255], v[116:119], v[208:223]
  v_mfma_f32_16x16x32_bf16 v[244:247], v[240:243], v[116:119], v[244:247]
  v_exp_f32 v39, v39
  ds_read_b128 a[220:223], v23 offset:57344
  v_mfma_f32_32x32x16_bf16 a[0:15], a[224:227], v[120:123], a[0:15]
  v_exp_f32 v40, v40
  v_cvt_pk_bf16_f32 v99, v38, v39
  s_add_u32 m0, s12, 49152
  v_mfma_f32_32x32x16_bf16 a[16:31], a[232:235], v[120:123], a[16:31]
  v_exp_f32 v41, v41
  s_add_u32 s13, s72, 65536
  buffer_load_dwordx4 v13, s[48:51], s13 offen lds
  v_mfma_f32_32x32x16_bf16 a[32:47], a[240:243], v[120:123], a[32:47]
  v_exp_f32 v42, v42
  v_cvt_pk_bf16_f32 v100, v40, v41
  s_add_u32 m0, s12, 50176
  s_add_u32 s13, s72, 69632
  v_mfma_f32_32x32x16_bf16 a[48:63], a[248:251], v[120:123], a[48:63]
  v_mfma_f32_16x16x32_bf16 v[248:251], v[240:243], v[120:123], v[248:251]
  v_exp_f32 v43, v43
  buffer_load_dwordx4 v13, s[48:51], s13 offen lds
  s_add_u32 m0, s12, 81920
  v_mfma_f32_32x32x16_bf16 a[0:15], a[228:231], v[124:127], a[0:15]
  v_exp_f32 v44, v44
  v_cvt_pk_bf16_f32 v101, v42, v43
  s_add_u32 s13, s73, 65536
  v_mfma_f32_32x32x16_bf16 a[16:31], a[236:239], v[124:127], a[16:31]
  v_exp_f32 v45, v45
  buffer_load_dwordx4 v13, s[48:51], s13 offen lds
  s_add_u32 m0, s12, 82944
  v_mfma_f32_32x32x16_bf16 a[32:47], a[244:247], v[124:127], a[32:47]
  v_exp_f32 v46, v46
  v_cvt_pk_bf16_f32 v102, v44, v45
  s_add_u32 s13, s73, 69632
  buffer_load_dwordx4 v13, s[48:51], s13 offen lds
  v_mfma_f32_32x32x16_bf16 a[48:63], a[252:255], v[124:127], a[48:63]
  v_mfma_f32_16x16x32_bf16 v[248:251], v[240:243], v[124:127], v[248:251]
  v_exp_f32 v47, v47
  s_add_u32 s13, s77, 10240
  buffer_load_dword v252, v236, s[52:55], s13 offen
  s_nop 0
  v_cvt_pk_bf16_f32 v103, v46, v47
  s_waitcnt lgkmcnt(0)
  v_mfma_f32_32x32x16_bf16 v[64:79], a[192:195], a[128:131], v[128:143]
  s_waitcnt vmcnt(20) lgkmcnt(0)
  s_barrier
  v_exp_f32 v48, v48
  v_mfma_f32_32x32x16_bf16 v[64:79], a[196:199], a[132:135], v[64:79]
  v_exp_f32 v49, v49
  ds_read_b64_tr_b16 a[224:225], v24 offset:49152
  v_mfma_f32_32x32x16_bf16 v[64:79], a[200:203], a[136:139], v[64:79]
  v_exp_f32 v50, v50
  v_cvt_pk_bf16_f32 v104, v48, v49
  ds_read_b64_tr_b16 a[226:227], v24 offset:51200
  v_mfma_f32_32x32x16_bf16 v[64:79], a[204:207], a[140:143], v[64:79]
  v_exp_f32 v51, v51
  ds_read_b64_tr_b16 a[232:233], v25 offset:49152
  ds_read_b64_tr_b16 a[234:235], v25 offset:51200
  v_mfma_f32_32x32x16_bf16 v[64:79], a[208:211], a[144:147], v[64:79]
  v_exp_f32 v52, v52
  v_cvt_pk_bf16_f32 v105, v50, v51
  ds_read_b64_tr_b16 a[240:241], v26 offset:49152
  v_mfma_f32_32x32x16_bf16 v[64:79], a[212:215], a[148:151], v[64:79]
  v_exp_f32 v53, v53
  ds_read_b64_tr_b16 a[242:243], v26 offset:51200
  ds_read_b64_tr_b16 a[248:249], v27 offset:49152
  v_mfma_f32_32x32x16_bf16 v[64:79], a[216:219], a[152:155], v[64:79]
  v_exp_f32 v54, v54
  v_cvt_pk_bf16_f32 v106, v52, v53
  ds_read_b64_tr_b16 a[250:251], v27 offset:51200
  v_mfma_f32_32x32x16_bf16 v[64:79], a[220:223], a[156:159], v[64:79]
  v_exp_f32 v55, v55
  ds_read_b64_tr_b16 a[228:229], v24 offset:53248
  ds_read_b64_tr_b16 a[230:231], v24 offset:55296
  v_mfma_f32_32x32x16_bf16 v[80:95], a[192:195], a[160:163], v[144:159]
  v_exp_f32 v56, v56
  v_cvt_pk_bf16_f32 v107, v54, v55
  ds_read_b64_tr_b16 a[236:237], v25 offset:53248
  v_mfma_f32_32x32x16_bf16 v[80:95], a[196:199], a[164:167], v[80:95]
  v_exp_f32 v57, v57
  ds_read_b64_tr_b16 a[238:239], v25 offset:55296
  ds_read_b64_tr_b16 a[244:245], v26 offset:53248
  v_mfma_f32_32x32x16_bf16 v[80:95], a[200:203], a[168:171], v[80:95]
  v_exp_f32 v58, v58
  v_cvt_pk_bf16_f32 v108, v56, v57
  ds_read_b64_tr_b16 a[246:247], v26 offset:55296
  v_mfma_f32_32x32x16_bf16 v[80:95], a[204:207], a[172:175], v[80:95]
  v_exp_f32 v59, v59
  ds_read_b64_tr_b16 a[252:253], v27 offset:53248
  ds_read_b64_tr_b16 a[254:255], v27 offset:55296
  v_mfma_f32_32x32x16_bf16 v[80:95], a[208:211], a[176:179], v[80:95]
  v_exp_f32 v60, v60
  v_cvt_pk_bf16_f32 v109, v58, v59
  v_mfma_f32_32x32x16_bf16 v[80:95], a[212:215], a[180:183], v[80:95]
  v_exp_f32 v61, v61
  v_mfma_f32_32x32x16_bf16 v[80:95], a[216:219], a[184:187], v[80:95]
  v_exp_f32 v62, v62
  v_cvt_pk_bf16_f32 v110, v60, v61
  v_mfma_f32_32x32x16_bf16 v[80:95], a[220:223], a[188:191], v[80:95]
  v_exp_f32 v63, v63
  s_nop 0
  v_cvt_pk_bf16_f32 v111, v62, v63
  s_waitcnt lgkmcnt(0)
  v_mfma_f32_32x32x16_bf16 v[160:175], a[224:227], v[96:99], v[160:175]
  v_exp_f32 v64, v64
  v_mfma_f32_32x32x16_bf16 v[176:191], a[232:235], v[96:99], v[176:191]
  v_exp_f32 v65, v65
  v_mfma_f32_32x32x16_bf16 v[192:207], a[240:243], v[96:99], v[192:207]
  v_exp_f32 v66, v66
  v_cvt_pk_bf16_f32 v112, v64, v65
  v_mfma_f32_32x32x16_bf16 v[208:223], a[248:251], v[96:99], v[208:223]
  v_mfma_f32_16x16x32_bf16 v[244:247], v[240:243], v[96:99], v[244:247]
  v_exp_f32 v67, v67
  v_mfma_f32_32x32x16_bf16 v[160:175], a[228:231], v[100:103], v[160:175]
  v_exp_f32 v68, v68
  v_cvt_pk_bf16_f32 v113, v66, v67
  v_mfma_f32_32x32x16_bf16 v[176:191], a[236:239], v[100:103], v[176:191]
  v_exp_f32 v69, v69
  v_mfma_f32_32x32x16_bf16 v[192:207], a[244:247], v[100:103], v[192:207]
  v_exp_f32 v70, v70
  v_cvt_pk_bf16_f32 v114, v68, v69
  v_mfma_f32_32x32x16_bf16 v[208:223], a[252:255], v[100:103], v[208:223]
  v_mfma_f32_16x16x32_bf16 v[244:247], v[240:243], v[100:103], v[244:247]
  v_exp_f32 v71, v71
  v_mfma_f32_32x32x16_bf16 a[0:15], a[224:227], v[104:107], a[0:15]
  v_exp_f32 v72, v72
  v_cvt_pk_bf16_f32 v115, v70, v71
  s_add_u32 m0, s12, 57344
  v_mfma_f32_32x32x16_bf16 a[16:31], a[232:235], v[104:107], a[16:31]
  v_exp_f32 v73, v73
  s_add_u32 s13, s72, 98304
  buffer_load_dwordx4 v13, s[48:51], s13 offen lds
  v_mfma_f32_32x32x16_bf16 a[32:47], a[240:243], v[104:107], a[32:47]
  v_exp_f32 v74, v74
  v_cvt_pk_bf16_f32 v116, v72, v73
  s_add_u32 m0, s12, 58368
  s_add_u32 s13, s72, 102400
  v_mfma_f32_32x32x16_bf16 a[48:63], a[248:251], v[104:107], a[48:63]
  v_mfma_f32_16x16x32_bf16 v[248:251], v[240:243], v[104:107], v[248:251]
  v_exp_f32 v75, v75
  buffer_load_dwordx4 v13, s[48:51], s13 offen lds
  s_add_u32 m0, s12, 90112
  v_mfma_f32_32x32x16_bf16 a[0:15], a[228:231], v[108:111], a[0:15]
  v_exp_f32 v76, v76
  v_cvt_pk_bf16_f32 v117, v74, v75
  s_add_u32 s13, s73, 98304
  v_mfma_f32_32x32x16_bf16 a[16:31], a[236:239], v[108:111], a[16:31]
  v_exp_f32 v77, v77
  buffer_load_dwordx4 v13, s[48:51], s13 offen lds
  s_add_u32 m0, s12, 91136
  v_mfma_f32_32x32x16_bf16 a[32:47], a[244:247], v[108:111], a[32:47]
  v_exp_f32 v78, v78
  v_cvt_pk_bf16_f32 v118, v76, v77
  s_add_u32 s13, s73, 102400
  buffer_load_dwordx4 v13, s[48:51], s13 offen lds
  v_mfma_f32_32x32x16_bf16 a[48:63], a[252:255], v[108:111], a[48:63]
  v_mfma_f32_16x16x32_bf16 v[248:251], v[240:243], v[108:111], v[248:251]
  v_exp_f32 v79, v79
  s_add_u32 s13, s77, 12288
  buffer_load_dword v253, v236, s[52:55], s13 offen
  s_nop 0
  v_cvt_pk_bf16_f32 v119, v78, v79
  s_waitcnt vmcnt(23) lgkmcnt(0)
  s_barrier
  ds_read_b64_tr_b16 a[224:225], v24 offset:57344
  ds_read_b64_tr_b16 a[226:227], v24 offset:59392
  ds_read_b64_tr_b16 a[232:233], v25 offset:57344
  ds_read_b64_tr_b16 a[234:235], v25 offset:59392
  ds_read_b64_tr_b16 a[240:241], v26 offset:57344
  ds_read_b64_tr_b16 a[242:243], v26 offset:59392
  ds_read_b64_tr_b16 a[248:249], v27 offset:57344
  ds_read_b64_tr_b16 a[250:251], v27 offset:59392
  ds_read_b64_tr_b16 a[228:229], v24 offset:61440
  ds_read_b64_tr_b16 a[230:231], v24 offset:63488
  ds_read_b64_tr_b16 a[236:237], v25 offset:61440
  ds_read_b64_tr_b16 a[238:239], v25 offset:63488
  ds_read_b64_tr_b16 a[244:245], v26 offset:61440
  ds_read_b64_tr_b16 a[246:247], v26 offset:63488
  ds_read_b64_tr_b16 a[252:253], v27 offset:61440
  ds_read_b64_tr_b16 a[254:255], v27 offset:63488
  v_add_u32 v8, 0x1a000, v14
  v_exp_f32 v80, v80
  v_exp_f32 v81, v81
  v_exp_f32 v82, v82
  v_cvt_pk_bf16_f32 v120, v80, v81
  v_exp_f32 v83, v83
  v_exp_f32 v84, v84
  v_cvt_pk_bf16_f32 v121, v82, v83
  s_add_u32 s13, s77, 14336
  buffer_load_dword v254, v236, s[52:55], s13 offen
  s_waitcnt lgkmcnt(0)
  v_mfma_f32_32x32x16_bf16 v[160:175], a[224:227], v[112:115], v[160:175]
  v_exp_f32 v85, v85
  v_exp_f32 v86, v86
  v_mfma_f32_32x32x16_bf16 v[176:191], a[232:235], v[112:115], v[176:191]
  v_cvt_pk_bf16_f32 v122, v84, v85
  v_exp_f32 v87, v87
  v_mfma_f32_32x32x16_bf16 v[192:207], a[240:243], v[112:115], v[192:207]
  v_exp_f32 v88, v88
  v_cvt_pk_bf16_f32 v123, v86, v87
  v_mfma_f32_32x32x16_bf16 v[208:223], a[248:251], v[112:115], v[208:223]
  v_mfma_f32_16x16x32_bf16 v[244:247], v[240:243], v[112:115], v[244:247]
  v_exp_f32 v89, v89
  v_exp_f32 v90, v90
  v_cvt_pk_bf16_f32 v124, v88, v89
  v_mfma_f32_32x32x16_bf16 v[160:175], a[228:231], v[116:119], v[160:175]
  v_exp_f32 v91, v91
  v_exp_f32 v92, v92
  v_mfma_f32_32x32x16_bf16 v[176:191], a[236:239], v[116:119], v[176:191]
  v_cvt_pk_bf16_f32 v125, v90, v91
  v_exp_f32 v93, v93
  v_mfma_f32_32x32x16_bf16 v[192:207], a[244:247], v[116:119], v[192:207]
  v_exp_f32 v94, v94
  v_cvt_pk_bf16_f32 v126, v92, v93
  v_mfma_f32_32x32x16_bf16 v[208:223], a[252:255], v[116:119], v[208:223]
  v_mfma_f32_16x16x32_bf16 v[244:247], v[240:243], v[116:119], v[244:247]
  v_exp_f32 v95, v95
  s_nop 0
  v_cvt_pk_bf16_f32 v127, v94, v95
  v_mfma_f32_32x32x16_bf16 a[0:15], a[224:227], v[120:123], a[0:15]
  v_mfma_f32_16x16x32_bf16 v[248:251], v[240:243], v[120:123], v[248:251]
  v_mfma_f32_32x32x16_bf16 a[16:31], a[232:235], v[120:123], a[16:31]
  v_mfma_f32_32x32x16_bf16 a[32:47], a[240:243], v[120:123], a[32:47]
  v_cvt_pk_bf16_f32 v32, v160, v161
  v_cvt_pk_bf16_f32 v33, v162, v163
  v_cvt_pk_bf16_f32 v34, v164, v165
  v_cvt_pk_bf16_f32 v35, v166, v167
  v_cvt_pk_bf16_f32 v36, v168, v169
  v_cvt_pk_bf16_f32 v37, v170, v171
  v_cvt_pk_bf16_f32 v38, v172, v173
  v_cvt_pk_bf16_f32 v39, v174, v175
  s_nop 0
  s_cmp_eq_u32 s76, 1
  s_cbranch_scc1 L_pg_15
  s_cmp_eq_u32 s76, 2
  s_cbranch_scc1 L_pl_16
  s_add_u32 s68, s77, 0
  buffer_store_dwordx4 v[32:35], v14, s[52:55], s68 offen
  s_add_u32 s68, s77, 1024
  buffer_store_dwordx4 v[36:39], v14, s[52:55], s68 offen
  s_branch L_pe_17
L_pg_15:
  s_add_u32 s68, s77, 0
  buffer_store_dwordx4 v[32:35], v14, s[52:55], s68 offen sc0 sc1
  s_add_u32 s68, s77, 1024
  buffer_store_dwordx4 v[36:39], v14, s[52:55], s68 offen sc0 sc1
  s_branch L_pe_17
L_pl_16:
  ds_write_b128 v8, v[32:35] offset:0
  ds_write_b128 v8, v[36:39] offset:1024
L_pe_17:
  v_mfma_f32_32x32x16_bf16 a[48:63], a[248:251], v[120:123], a[48:63]
  v_cvt_pk_bf16_f32 v40, v176, v177
  v_cvt_pk_bf16_f32 v41, v178, v179
  v_cvt_pk_bf16_f32 v42, v180, v181
  v_cvt_pk_bf16_f32 v43, v182, v183
  v_cvt_pk_bf16_f32 v44, v184, v185
  v_cvt_pk_bf16_f32 v45, v186, v187
  v_cvt_pk_bf16_f32 v46, v188, v189
  v_cvt_pk_bf16_f32 v47, v190, v191
  s_nop 0
  s_cmp_eq_u32 s76, 1
  s_cbranch_scc1 L_pg_18
  s_cmp_eq_u32 s76, 2
  s_cbranch_scc1 L_pl_19
  s_add_u32 s68, s77, 2048
  buffer_store_dwordx4 v[40:43], v14, s[52:55], s68 offen
  s_add_u32 s68, s77, 3072
  buffer_store_dwordx4 v[44:47], v14, s[52:55], s68 offen
  s_branch L_pe_20
L_pg_18:
  s_add_u32 s68, s77, 2048
  buffer_store_dwordx4 v[40:43], v14, s[52:55], s68 offen sc0 sc1
  s_add_u32 s68, s77, 3072
  buffer_store_dwordx4 v[44:47], v14, s[52:55], s68 offen sc0 sc1
  s_branch L_pe_20
L_pl_19:
  ds_write_b128 v8, v[40:43] offset:2048
  ds_write_b128 v8, v[44:47] offset:3072
L_pe_20:
  v_mfma_f32_32x32x16_bf16 a[0:15], a[228:231], v[124:127], a[0:15]
  v_mfma_f32_16x16x32_bf16 v[248:251], v[240:243], v[124:127], v[248:251]
  v_cvt_pk_bf16_f32 v48, v192, v193
  v_cvt_pk_bf16_f32 v49, v194, v195
  v_cvt_pk_bf16_f32 v50, v196, v197
  v_cvt_pk_bf16_f32 v51, v198, v199
  v_cvt_pk_bf16_f32 v52, v200, v201
  v_cvt_pk_bf16_f32 v53, v202, v203
  v_cvt_pk_bf16_f32 v54, v204, v205
  v_cvt_pk_bf16_f32 v55, v206, v207
  s_nop 0
  s_cmp_eq_u32 s76, 1
  s_cbranch_scc1 L_pg_21
  s_cmp_eq_u32 s76, 2
  s_cbranch_scc1 L_pl_22
  s_add_u32 s68, s77, 4096
  buffer_store_dwordx4 v[48:51], v14, s[52:55], s68 offen
  s_add_u32 s68, s77, 5120
  buffer_store_dwordx4 v[52:55], v14, s[52:55], s68 offen
  s_branch L_pe_23
L_pg_21:
  s_add_u32 s68, s77, 4096
  buffer_store_dwordx4 v[48:51], v14, s[52:55], s68 offen sc0 sc1
  s_add_u32 s68, s77, 5120
  buffer_store_dwordx4 v[52:55], v14, s[52:55], s68 offen sc0 sc1
  s_branch L_pe_23
L_pl_22:
  ds_write_b128 v8, v[48:51] offset:4096
  ds_write_b128 v8, v[52:55] offset:5120
L_pe_23:
  v_mfma_f32_32x32x16_bf16 a[16:31], a[236:239], v[124:127], a[16:31]
  v_cvt_pk_bf16_f32 v56, v208, v209
  v_cvt_pk_bf16_f32 v57, v210, v211
  v_cvt_pk_bf16_f32 v58, v212, v213
  v_cvt_pk_bf16_f32 v59, v214, v215
  v_cvt_pk_bf16_f32 v60, v216, v217
  v_cvt_pk_bf16_f32 v61, v218, v219
  v_cvt_pk_bf16_f32 v62, v220, v221
  v_cvt_pk_bf16_f32 v63, v222, v223
  s_nop 0
  s_cmp_eq_u32 s76, 1
  s_cbranch_scc1 L_pg_24
  s_cmp_eq_u32 s76, 2
  s_cbranch_scc1 L_pl_25
  s_add_u32 s68, s77, 6144
  buffer_store_dwordx4 v[56:59], v14, s[52:55], s68 offen
  s_add_u32 s68, s77, 7168
  buffer_store_dwordx4 v[60:63], v14, s[52:55], s68 offen
  s_branch L_pe_26
L_pg_24:
  s_add_u32 s68, s77, 6144
  buffer_store_dwordx4 v[56:59], v14, s[52:55], s68 offen sc0 sc1
  s_add_u32 s68, s77, 7168
  buffer_store_dwordx4 v[60:63], v14, s[52:55], s68 offen sc0 sc1
  s_branch L_pe_26
L_pl_25:
  ds_write_b128 v8, v[56:59] offset:6144
  ds_write_b128 v8, v[60:63] offset:7168
L_pe_26:
  v_mfma_f32_32x32x16_bf16 a[32:47], a[244:247], v[124:127], a[32:47]
  v_mfma_f32_32x32x16_bf16 a[48:63], a[252:255], v[124:127], a[48:63]
  s_nop 7
  v_permlane16_swap_b32 v244, v245
  v_permlane16_swap_b32 v248, v249
  s_nop 1
  v_mov_b32 v28, v244
  v_mov_b32 v29, v248
  v_max_f32 v4, v28, v29
  v_add_f32 v5, v28, v29
  s_mov_b32 s64, 0x4b800000
  v_cmp_nge_f32 vcc, s64, v4
  v_cmp_u_f32 s[66:67], v5, v5
  s_nop 4
  s_or_b64 vcc, vcc, s[66:67]
  s_cselect_b32 s65, 1, 0
  v_mov_b32 v4, s65
  s_lshl_b32 s66, s3, 2
  v_mov_b32 v5, s66
  v_add_u32 v5, 0x18000, v5
  ds_write_b32 v5, v4
  s_waitcnt lgkmcnt(0)
  s_barrier
  v_mov_b32 v1, 0x18000
  ds_read_b128 v[240:243], v1
  v_accvgpr_read_b32 v96, a0
  v_accvgpr_read_b32 v97, a1
  v_accvgpr_read_b32 v98, a2
  v_accvgpr_read_b32 v99, a3
  v_accvgpr_read_b32 v100, a4
  v_accvgpr_read_b32 v101, a5
  v_accvgpr_read_b32 v102, a6
  v_accvgpr_read_b32 v103, a7
  v_accvgpr_read_b32 v104, a8
  v_accvgpr_read_b32 v105, a9
  v_accvgpr_read_b32 v106, a10
  v_accvgpr_read_b32 v107, a11
  v_accvgpr_read_b32 v108, a12
  v_accvgpr_read_b32 v109, a13
  v_accvgpr_read_b32 v110, a14
  v_accvgpr_read_b32 v111, a15
  v_cvt_pk_bf16_f32 v64, v96, v97
  v_cvt_pk_bf16_f32 v65, v98, v99
  v_cvt_pk_bf16_f32 v66, v100, v101
  v_cvt_pk_bf16_f32 v67, v102, v103
  v_cvt_pk_bf16_f32 v68, v104, v105
  v_cvt_pk_bf16_f32 v69, v106, v107
  v_cvt_pk_bf16_f32 v70, v108, v109
  v_cvt_pk_bf16_f32 v71, v110, v111
  s_nop 0
  s_cmp_eq_u32 s76, 1
  s_cbranch_scc1 L_pg_27
  s_cmp_eq_u32 s76, 2
  s_cbranch_scc1 L_pl_28
  s_add_u32 s68, s77, 8192
  buffer_store_dwordx4 v[64:67], v14, s[52:55], s68 offen
  s_add_u32 s68, s77, 9216
  buffer_store_dwordx4 v[68:71], v14, s[52:55], s68 offen
  s_branch L_pe_29
L_pg_27:
  s_add_u32 s68, s77, 8192
  buffer_store_dwordx4 v[64:67], v14, s[52:55], s68 offen sc0 sc1
  s_add_u32 s68, s77, 9216
  buffer_store_dwordx4 v[68:71], v14, s[52:55], s68 offen sc0 sc1
  s_branch L_pe_29
L_pl_28:
  ds_write_b128 v8, v[64:67] offset:8192
  ds_write_b128 v8, v[68:71] offset:9216
L_pe_29:
  v_accvgpr_read_b32 v96, a16
  v_accvgpr_read_b32 v97, a17
  v_accvgpr_read_b32 v98, a18
  v_accvgpr_read_b32 v99, a19
  v_accvgpr_read_b32 v100, a20
  v_accvgpr_read_b32 v101, a21
  v_accvgpr_read_b32 v102, a22
  v_accvgpr_read_b32 v103, a23
  v_accvgpr_read_b32 v104, a24
  v_accvgpr_read_b32 v105, a25
  v_accvgpr_read_b32 v106, a26
  v_accvgpr_read_b32 v107, a27
  v_accvgpr_read_b32 v108, a28
  v_accvgpr_read_b32 v109, a29
  v_accvgpr_read_b32 v110, a30
  v_accvgpr_read_b32 v111, a31
  v_cvt_pk_bf16_f32 v72, v96, v97
  v_cvt_pk_bf16_f32 v73, v98, v99
  v_cvt_pk_bf16_f32 v74, v100, v101
  v_cvt_pk_bf16_f32 v75, v102, v103
  v_cvt_pk_bf16_f32 v76, v104, v105
  v_cvt_pk_bf16_f32 v77, v106, v107
  v_cvt_pk_bf16_f32 v78, v108, v109
  v_cvt_pk_bf16_f32 v79, v110, v111
  s_nop 0
  s_cmp_eq_u32 s76, 1
  s_cbranch_scc1 L_pg_30
  s_cmp_eq_u32 s76, 2
  s_cbranch_scc1 L_pl_31
  s_add_u32 s68, s77, 10240
  buffer_store_dwordx4 v[72:75], v14, s[52:55], s68 offen
  s_add_u32 s68, s77, 11264
  buffer_store_dwordx4 v[76:79], v14, s[52:55], s68 offen
  s_branch L_pe_32
L_pg_30:
  s_add_u32 s68, s77, 10240
  buffer_store_dwordx4 v[72:75], v14, s[52:55], s68 offen sc0 sc1
  s_add_u32 s68, s77, 11264
  buffer_store_dwordx4 v[76:79], v14, s[52:55], s68 offen sc0 sc1
  s_branch L_pe_32
L_pl_31:
  ds_write_b128 v8, v[72:75] offset:10240
  ds_write_b128 v8, v[76:79] offset:11264
L_pe_32:
  v_accvgpr_read_b32 v96, a32
  v_accvgpr_read_b32 v97, a33
  v_accvgpr_read_b32 v98, a34
  v_accvgpr_read_b32 v99, a35
  v_accvgpr_read_b32 v100, a36
  v_accvgpr_read_b32 v101, a37
  v_accvgpr_read_b32 v102, a38
  v_accvgpr_read_b32 v103, a39
  v_accvgpr_read_b32 v104, a40
  v_accvgpr_read_b32 v105, a41
  v_accvgpr_read_b32 v106, a42
  v_accvgpr_read_b32 v107, a43
  v_accvgpr_read_b32 v108, a44
  v_accvgpr_read_b32 v109, a45
  v_accvgpr_read_b32 v110, a46
  v_accvgpr_read_b32 v111, a47
  v_cvt_pk_bf16_f32 v80, v96, v97
  v_cvt_pk_bf16_f32 v81, v98, v99
  v_cvt_pk_bf16_f32 v82, v100, v101
  v_cvt_pk_bf16_f32 v83, v102, v103
  v_cvt_pk_bf16_f32 v84, v104, v105
  v_cvt_pk_bf16_f32 v85, v106, v107
  v_cvt_pk_bf16_f32 v86, v108, v109
  v_cvt_pk_bf16_f32 v87, v110, v111
  s_nop 0
  s_cmp_eq_u32 s76, 1
  s_cbranch_scc1 L_pg_33
  s_cmp_eq_u32 s76, 2
  s_cbranch_scc1 L_pl_34
  s_add_u32 s68, s77, 12288
  buffer_store_dwordx4 v[80:83], v14, s[52:55], s68 offen
  s_add_u32 s68, s77, 13312
  buffer_store_dwordx4 v[84:87], v14, s[52:55], s68 offen
  s_branch L_pe_35
L_pg_33:
  s_add_u32 s68, s77, 12288
  buffer_store_dwordx4 v[80:83], v14, s[52:55], s68 offen sc0 sc1
  s_add_u32 s68, s77, 13312
  buffer_store_dwordx4 v[84:87], v14, s[52:55], s68 offen sc0 sc1
  s_branch L_pe_35
L_pl_34:
  ds_write_b128 v8, v[80:83] offset:12288
  ds_write_b128 v8, v[84:87] offset:13312
L_pe_35:
  v_accvgpr_read_b32 v96, a48
  v_accvgpr_read_b32 v97, a49
  v_accvgpr_read_b32 v98, a50
  v_accvgpr_read_b32 v99, a51
  v_accvgpr_read_b32 v100, a52
  v_accvgpr_read_b32 v101, a53
  v_accvgpr_read_b32 v102, a54
  v_accvgpr_read_b32 v103, a55
  v_accvgpr_read_b32 v104, a56
  v_accvgpr_read_b32 v105, a57
  v_accvgpr_read_b32 v106, a58
  v_accvgpr_read_b32 v107, a59
  v_accvgpr_read_b32 v108, a60
  v_accvgpr_read_b32 v109, a61
  v_accvgpr_read_b32 v110, a62
  v_accvgpr_read_b32 v111, a63
  v_cvt_pk_bf16_f32 v88, v96, v97
  v_cvt_pk_bf16_f32 v89, v98, v99
  v_cvt_pk_bf16_f32 v90, v100, v101
  v_cvt_pk_bf16_f32 v91, v102, v103
  v_cvt_pk_bf16_f32 v92, v104, v105
  v_cvt_pk_bf16_f32 v93, v106, v107
  v_cvt_pk_bf16_f32 v94, v108, v109
  v_cvt_pk_bf16_f32 v95, v110, v111
  s_nop 0
  s_cmp_eq_u32 s76, 1
  s_cbranch_scc1 L_pg_36
  s_cmp_eq_u32 s76, 2
  s_cbranch_scc1 L_pl_37
  s_add_u32 s68, s77, 14336
  buffer_store_dwordx4 v[88:91], v14, s[52:55], s68 offen
  s_add_u32 s68, s77, 15360
  buffer_store_dwordx4 v[92:95], v14, s[52:55], s68 offen
  s_branch L_pe_38
L_pg_36:
  s_add_u32 s68, s77, 14336
  buffer_store_dwordx4 v[88:91], v14, s[52:55], s68 offen sc0 sc1
  s_add_u32 s68, s77, 15360
  buffer_store_dwordx4 v[92:95], v14, s[52:55], s68 offen sc0 sc1
  s_branch L_pe_38
L_pl_37:
  ds_write_b128 v8, v[88:91] offset:14336
  ds_write_b128 v8, v[92:95] offset:15360
L_pe_38:
  v_mov_b32 v4, v30
  v_mov_b32 v5, v28
  v_mov_b32 v6, v31
  v_mov_b32 v7, v29
  s_cmp_eq_u32 s9, 0
  s_cbranch_scc1 L_sg_39
  s_mov_b32 exec_hi, 0
  buffer_store_dwordx4 v[4:7], v14, s[52:55], s78 offen
  s_mov_b32 exec_hi, -1
  s_branch L_se_40
L_sg_39:
  s_mov_b32 exec_hi, 0
  buffer_store_dwordx4 v[4:7], v14, s[52:55], s78 offen sc0 sc1
  s_mov_b32 exec_hi, -1
L_se_40:
  s_lshl_b32 s66, s11, 9
  s_lshl_b32 s67, s3, 7
  s_add_u32 s67, s67, s66
  s_lshl_b32 s68, s6, 2
  s_add_u32 s67, s67, s68
  s_add_u32 s67, s67, 34619392
  s_waitcnt lgkmcnt(0)
  v_or_b32 v240, v240, v241
  v_or3_b32 v240, v240, v242, v243
  s_nop 0
  v_readfirstlane_b32 s65, v240
  s_nop 3
  s_cmp_lg_u32 s65, 0
  s_cbranch_scc1 L_safe
L_safe_back:
  s_waitcnt vmcnt(0) lgkmcnt(0)
  v_mov_b32 v4, s8
  v_mov_b32 v5, 0
  s_mov_b64 exec, 1
  s_cmp_eq_u32 s9, 0
  s_cbranch_scc1 L_fg_41
  buffer_store_dword v4, v5, s[52:55], s67 offen
  s_branch L_fe_42
L_fg_41:
  buffer_store_dword v4, v5, s[52:55], s67 offen sc0 sc1
L_fe_42:
  s_mov_b64 exec, -1
  s_barrier
  s_lshl_b32 s68, s3, 11
  v_add_u32 v8, s68, v14
  v_add_u32 v8, 0x1a000, v8
  s_lshl_b32 s67, s6, 7
  s_add_u32 s67, s67, s66
  s_add_u32 s67, s67, 34619392
  ds_read_b128 v[208:211], v8 offset:0
  ds_read_b128 v[212:215], v8 offset:1024
  ds_read_b128 v[216:219], v8 offset:8192
  ds_read_b128 v[220:223], v8 offset:9216
  s_lshl_b32 s64, s11, 2
  s_add_u32 s64, s64, s6
  s_lshl_b32 s64, s64, 2
  s_lshl_b32 s65, s64, 14
  s_add_u32 s65, s65, s12
  s_lshl_b32 s66, s64, 9
  v_and_b32 v2, 31, v0
  v_lshlrev_b32 v2, 4, v2
  s_lshl_b32 s68, s3, 2
  v_bfe_u32 v4, v0, 4, 1
  v_and_b32 v5, 3, v0
  v_and_b32 v6, 1, v5
  v_lshrrev_b32 v5, 1, v5
  v_lshl_add_u32 v6, v4, 1, v6
  v_add_u32 v6, s68, v6
  v_bfe_u32 v4, v0, 2, 2
  v_lshlrev_b32 v7, 2, v4
  v_xor_b32 v6, v6, v7
  v_lshlrev_b32 v6, 4, v6
  v_lshl_add_u32 v6, v5, 3, v6
  v_lshrrev_b32 v7, 5, v0
  v_lshl_add_u32 v7, v7, 2, v4
  v_lshl_add_u32 v192, v7, 8, v6
  v_add_u32 v193, 0x10000, v192
  v_add_u32 v194, 0x20000, v192
  ds_read_b64_tr_b16 a[128:129], v194 offset:0
  ds_read_b64_tr_b16 a[130:131], v194 offset:2048
  ds_read_b64_tr_b16 a[132:133], v194 offset:4096
  ds_read_b64_tr_b16 a[134:135], v194 offset:6144
  ds_read_b64_tr_b16 a[136:137], v194 offset:8192
  ds_read_b64_tr_b16 a[138:139], v194 offset:10240
  ds_read_b64_tr_b16 a[140:141], v194 offset:12288
  ds_read_b64_tr_b16 a[142:143], v194 offset:14336
  s_waitcnt lgkmcnt(4)
  ds_read_b64_tr_b16 a[144:145], v194 offset:16384
  ds_read_b64_tr_b16 a[146:147], v194 offset:18432
  ds_read_b64_tr_b16 a[148:149], v194 offset:20480
  ds_read_b64_tr_b16 a[150:151], v194 offset:22528
  ds_read_b64_tr_b16 a[152:153], v194 offset:24576
  ds_read_b64_tr_b16 a[154:155], v194 offset:26624
  ds_read_b64_tr_b16 a[156:157], v194 offset:28672
  ds_read_b64_tr_b16 a[158:159], v194 offset:30720
  s_waitcnt lgkmcnt(4)
  ds_read_b64_tr_b16 a[160:161], v192 offset:0
  ds_read_b64_tr_b16 a[162:163], v192 offset:2048
  ds_read_b64_tr_b16 a[164:165], v192 offset:4096
  ds_read_b64_tr_b16 a[166:167], v192 offset:6144
  ds_read_b64_tr_b16 a[168:169], v192 offset:8192
  ds_read_b64_tr_b16 a[170:171], v192 offset:10240
  ds_read_b64_tr_b16 a[172:173], v192 offset:12288
  ds_read_b64_tr_b16 a[174:175], v192 offset:14336
  s_waitcnt lgkmcnt(4)
  ds_read_b64_tr_b16 a[176:177], v192 offset:16384
  ds_read_b64_tr_b16 a[178:179], v192 offset:18432
  ds_read_b64_tr_b16 a[180:181], v192 offset:20480
  ds_read_b64_tr_b16 a[182:183], v192 offset:22528
  ds_read_b64_tr_b16 a[184:185], v192 offset:24576
  ds_read_b64_tr_b16 a[186:187], v192 offset:26624
  ds_read_b64_tr_b16 a[188:189], v192 offset:28672
  ds_read_b64_tr_b16 a[190:191], v192 offset:30720
  s_waitcnt lgkmcnt(4)
  ds_read_b64_tr_b16 a[192:193], v192 offset:32768
  ds_read_b64_tr_b16 a[194:195], v192 offset:34816
  ds_read_b64_tr_b16 a[196:197], v192 offset:36864
  ds_read_b64_tr_b16 a[198:199], v192 offset:38912
  ds_read_b64_tr_b16 a[200:201], v192 offset:40960
  ds_read_b64_tr_b16 a[202:203], v192 offset:43008
  ds_read_b64_tr_b16 a[204:205], v192 offset:45056
  ds_read_b64_tr_b16 a[206:207], v192 offset:47104
  s_waitcnt lgkmcnt(4)
  ds_read_b64_tr_b16 a[208:209], v192 offset:49152
  ds_read_b64_tr_b16 a[210:211], v192 offset:51200
  ds_read_b64_tr_b16 a[212:213], v192 offset:53248
  ds_read_b64_tr_b16 a[214:215], v192 offset:55296
  ds_read_b64_tr_b16 a[216:217], v192 offset:57344
  ds_read_b64_tr_b16 a[218:219], v192 offset:59392
  ds_read_b64_tr_b16 a[220:221], v192 offset:61440
  ds_read_b64_tr_b16 a[222:223], v192 offset:63488
  s_waitcnt lgkmcnt(4)
  ds_read_b64_tr_b16 a[224:225], v193 offset:0
  ds_read_b64_tr_b16 a[226:227], v193 offset:2048
  ds_read_b64_tr_b16 a[228:229], v193 offset:4096
  ds_read_b64_tr_b16 a[230:231], v193 offset:6144
  ds_read_b64_tr_b16 a[232:233], v193 offset:8192
  ds_read_b64_tr_b16 a[234:235], v193 offset:10240
  ds_read_b64_tr_b16 a[236:237], v193 offset:12288
  ds_read_b64_tr_b16 a[238:239], v193 offset:14336
  s_waitcnt lgkmcnt(4)
  ds_read_b64_tr_b16 a[240:241], v193 offset:16384
  ds_read_b64_tr_b16 a[242:243], v193 offset:18432
  ds_read_b64_tr_b16 a[244:245], v193 offset:20480
  ds_read_b64_tr_b16 a[246:247], v193 offset:22528
  ds_read_b64_tr_b16 a[248:249], v193 offset:24576
  ds_read_b64_tr_b16 a[250:251], v193 offset:26624
  ds_read_b64_tr_b16 a[252:253], v193 offset:28672
  ds_read_b64_tr_b16 a[254:255], v193 offset:30720
  s_mov_b32 s14, 65536
L_poll_43:
  buffer_load_dword v4, v15, s[52:55], s67 offen sc1
  s_sub_u32 s14, s14, 1
  s_cbranch_scc1 L_pollx_44
  s_waitcnt vmcnt(0)
  v_cmp_ne_u32 vcc, s8, v4
  s_nop 4
  s_and_b32 s79, vcc_lo, 0xf
  s_cbranch_scc1 L_poll_43
L_pollx_44:
  s_add_u32 s67, s66, 20971520
  buffer_load_dwordx4 v[128:131], v2, s[52:55], s67 offen sc1
  s_add_u32 s67, s66, 20972032
  buffer_load_dwordx4 v[132:135], v2, s[52:55], s67 offen sc1
  s_add_u32 s67, s66, 20972544
  buffer_load_dwordx4 v[136:139], v2, s[52:55], s67 offen sc1
  s_add_u32 s67, s66, 20973056
  buffer_load_dwordx4 v[140:143], v2, s[52:55], s67 offen sc1
  s_cmp_eq_u32 s6, 0
  s_cbranch_scc1 L_skipown_45
  s_add_u32 s67, s65, 4194304
  buffer_load_dwordx4 v[32:35], v14, s[52:55], s67 offen sc1
  s_add_u32 s67, s65, 4195328
  buffer_load_dwordx4 v[36:39], v14, s[52:55], s67 offen sc1
  s_add_u32 s67, s65, 4202496
  buffer_load_dwordx4 v[40:43], v14, s[52:55], s67 offen sc1
  s_add_u32 s67, s65, 4203520
  buffer_load_dwordx4 v[44:47], v14, s[52:55], s67 offen sc1
L_skipown_45:
  s_cmp_eq_u32 s6, 1
  s_cbranch_scc1 L_skipown_46
  s_add_u32 s67, s65, 4210688
  buffer_load_dwordx4 v[48:51], v14, s[52:55], s67 offen sc1
  s_add_u32 s67, s65, 4211712
  buffer_load_dwordx4 v[52:55], v14, s[52:55], s67 offen sc1
  s_add_u32 s67, s65, 4218880
  buffer_load_dwordx4 v[56:59], v14, s[52:55], s67 offen sc1
  s_add_u32 s67, s65, 4219904
  buffer_load_dwordx4 v[60:63], v14, s[52:55], s67 offen sc1
L_skipown_46:
  s_cmp_eq_u32 s6, 2
  s_cbranch_scc1 L_skipown_47
  s_add_u32 s67, s65, 4227072
  buffer_load_dwordx4 v[64:67], v14, s[52:55], s67 offen sc1
  s_add_u32 s67, s65, 4228096
  buffer_load_dwordx4 v[68:71], v14, s[52:55], s67 offen sc1
  s_add_u32 s67, s65, 4235264
  buffer_load_dwordx4 v[72:75], v14, s[52:55], s67 offen sc1
  s_add_u32 s67, s65, 4236288
  buffer_load_dwordx4 v[76:79], v14, s[52:55], s67 offen sc1
L_skipown_47:
  s_cmp_eq_u32 s6, 3
  s_cbranch_scc1 L_skipown_48
  s_add_u32 s67, s65, 4243456
  buffer_load_dwordx4 v[80:83], v14, s[52:55], s67 offen sc1
  s_add_u32 s67, s65, 4244480
  buffer_load_dwordx4 v[84:87], v14, s[52:55], s67 offen sc1
  s_add_u32 s67, s65, 4251648
  buffer_load_dwordx4 v[88:91], v14, s[52:55], s67 offen sc1
  s_add_u32 s67, s65, 4252672
  buffer_load_dwordx4 v[92:95], v14, s[52:55], s67 offen sc1
L_skipown_48:
  s_waitcnt vmcnt(12)
  v_max3_f32 v4, v128, v132, v136
  v_max_f32 v4, v4, v140
  v_sub_f32 v128, v128, v4
  v_sub_f32 v132, v132, v4
  v_sub_f32 v136, v136, v4
  v_sub_f32 v140, v140, v4
  v_exp_f32 v128, v128
  v_exp_f32 v132, v132
  v_exp_f32 v136, v136
  v_exp_f32 v140, v140
  s_nop 0
  v_mul_f32 v5, v128, v129
  v_fmac_f32 v5, v132, v133
  v_fmac_f32 v5, v136, v137
  v_fmac_f32 v5, v140, v141
  v_rcp_f32 v5, v5
  s_nop 0
  v_mul_f32 v128, v128, v5
  v_mul_f32 v132, v132, v5
  v_mul_f32 v136, v136, v5
  v_mul_f32 v140, v140, v5
  v_max3_f32 v4, v130, v134, v138
  v_max_f32 v4, v4, v142
  v_sub_f32 v130, v130, v4
  v_sub_f32 v134, v134, v4
  v_sub_f32 v138, v138, v4
  v_sub_f32 v142, v142, v4
  v_exp_f32 v130, v130
  v_exp_f32 v134, v134
  v_exp_f32 v138, v138
  v_exp_f32 v142, v142
  s_nop 0
  v_mul_f32 v5, v130, v131
  v_fmac_f32 v5, v134, v135
  v_fmac_f32 v5, v138, v139
  v_fmac_f32 v5, v142, v143
  v_rcp_f32 v5, v5
  s_nop 0
  v_mul_f32 v130, v130, v5
  v_mul_f32 v134, v134, v5
  v_mul_f32 v138, v138, v5
  v_mul_f32 v142, v142, v5
  s_cmp_lg_u32 s6, 0
  s_cbranch_scc1 L_ownsc_49
  v_mov_b32 v144, v128
  v_mov_b32 v146, v130
L_ownsc_49:
  s_cmp_lg_u32 s6, 1
  s_cbranch_scc1 L_ownsc_50
  v_mov_b32 v144, v132
  v_mov_b32 v146, v134
L_ownsc_50:
  s_cmp_lg_u32 s6, 2
  s_cbranch_scc1 L_ownsc_51
  v_mov_b32 v144, v136
  v_mov_b32 v146, v138
L_ownsc_51:
  s_cmp_lg_u32 s6, 3
  s_cbranch_scc1 L_ownsc_52
  v_mov_b32 v144, v140
  v_mov_b32 v146, v142
L_ownsc_52:
  s_mov_b32 s68, 0xffff0000
  s_waitcnt lgkmcnt(0)
  v_lshlrev_b32 v4, 16, v208
  v_and_b32 v5, s68, v208
  v_pk_mul_f32 v[96:97], v[4:5], v[144:145] op_sel_hi:[1,0]
  v_lshlrev_b32 v6, 16, v209
  v_and_b32 v7, s68, v209
  v_pk_mul_f32 v[98:99], v[6:7], v[144:145] op_sel_hi:[1,0]
  v_lshlrev_b32 v4, 16, v210
  v_and_b32 v5, s68, v210
  v_pk_mul_f32 v[100:101], v[4:5], v[144:145] op_sel_hi:[1,0]
  v_lshlrev_b32 v6, 16, v211
  v_and_b32 v7, s68, v211
  v_pk_mul_f32 v[102:103], v[6:7], v[144:145] op_sel_hi:[1,0]
  v_lshlrev_b32 v4, 16, v212
  v_and_b32 v5, s68, v212
  v_pk_mul_f32 v[104:105], v[4:5], v[144:145] op_sel_hi:[1,0]
  v_lshlrev_b32 v6, 16, v213
  v_and_b32 v7, s68, v213
  v_pk_mul_f32 v[106:107], v[6:7], v[144:145] op_sel_hi:[1,0]
  v_lshlrev_b32 v4, 16, v214
  v_and_b32 v5, s68, v214
  v_pk_mul_f32 v[108:109], v[4:5], v[144:145] op_sel_hi:[1,0]
  v_lshlrev_b32 v6, 16, v215
  v_and_b32 v7, s68, v215
  v_pk_mul_f32 v[110:111], v[6:7], v[144:145] op_sel_hi:[1,0]
  v_lshlrev_b32 v4, 16, v216
  v_and_b32 v5, s68, v216
  v_pk_mul_f32 v[112:113], v[4:5], v[146:147] op_sel_hi:[1,0]
  v_lshlrev_b32 v6, 16, v217
  v_and_b32 v7, s68, v217
  v_pk_mul_f32 v[114:115], v[6:7], v[146:147] op_sel_hi:[1,0]
  v_lshlrev_b32 v4, 16, v218
  v_and_b32 v5, s68, v218
  v_pk_mul_f32 v[116:117], v[4:5], v[146:147] op_sel_hi:[1,0]
  v_lshlrev_b32 v6, 16, v219
  v_and_b32 v7, s68, v219
  v_pk_mul_f32 v[118:119], v[6:7], v[146:147] op_sel_hi:[1,0]
  v_lshlrev_b32 v4, 16, v220
  v_and_b32 v5, s68, v220
  v_pk_mul_f32 v[120:121], v[4:5], v[146:147] op_sel_hi:[1,0]
  v_lshlrev_b32 v6, 16, v221
  v_and_b32 v7, s68, v221
  v_pk_mul_f32 v[122:123], v[6:7], v[146:147] op_sel_hi:[1,0]
  v_lshlrev_b32 v4, 16, v222
  v_and_b32 v5, s68, v222
  v_pk_mul_f32 v[124:125], v[4:5], v[146:147] op_sel_hi:[1,0]
  v_lshlrev_b32 v6, 16, v223
  v_and_b32 v7, s68, v223
  v_pk_mul_f32 v[126:127], v[6:7], v[146:147] op_sel_hi:[1,0]
  s_waitcnt vmcnt(0)
  s_cmp_eq_u32 s6, 0
  s_cbranch_scc1 L_skipown2_53
  v_lshlrev_b32 v4, 16, v32
  v_and_b32 v5, s68, v32
  v_pk_fma_f32 v[96:97], v[4:5], v[128:129], v[96:97] op_sel_hi:[1,0,1]
  v_lshlrev_b32 v6, 16, v33
  v_and_b32 v7, s68, v33
  v_pk_fma_f32 v[98:99], v[6:7], v[128:129], v[98:99] op_sel_hi:[1,0,1]
  v_lshlrev_b32 v4, 16, v34
  v_and_b32 v5, s68, v34
  v_pk_fma_f32 v[100:101], v[4:5], v[128:129], v[100:101] op_sel_hi:[1,0,1]
  v_lshlrev_b32 v6, 16, v35
  v_and_b32 v7, s68, v35
  v_pk_fma_f32 v[102:103], v[6:7], v[128:129], v[102:103] op_sel_hi:[1,0,1]
  v_lshlrev_b32 v4, 16, v36
  v_and_b32 v5, s68, v36
  v_pk_fma_f32 v[104:105], v[4:5], v[128:129], v[104:105] op_sel_hi:[1,0,1]
  v_lshlrev_b32 v6, 16, v37
  v_and_b32 v7, s68, v37
  v_pk_fma_f32 v[106:107], v[6:7], v[128:129], v[106:107] op_sel_hi:[1,0,1]
  v_lshlrev_b32 v4, 16, v38
  v_and_b32 v5, s68, v38
  v_pk_fma_f32 v[108:109], v[4:5], v[128:129], v[108:109] op_sel_hi:[1,0,1]
  v_lshlrev_b32 v6, 16, v39
  v_and_b32 v7, s68, v39
  v_pk_fma_f32 v[110:111], v[6:7], v[128:129], v[110:111] op_sel_hi:[1,0,1]
  v_lshlrev_b32 v4, 16, v40
  v_and_b32 v5, s68, v40
  v_pk_fma_f32 v[112:113], v[4:5], v[130:131], v[112:113] op_sel_hi:[1,0,1]
  v_lshlrev_b32 v6, 16, v41
  v_and_b32 v7, s68, v41
  v_pk_fma_f32 v[114:115], v[6:7], v[130:131], v[114:115] op_sel_hi:[1,0,1]
  v_lshlrev_b32 v4, 16, v42
  v_and_b32 v5, s68, v42
  v_pk_fma_f32 v[116:117], v[4:5], v[130:131], v[116:117] op_sel_hi:[1,0,1]
  v_lshlrev_b32 v6, 16, v43
  v_and_b32 v7, s68, v43
  v_pk_fma_f32 v[118:119], v[6:7], v[130:131], v[118:119] op_sel_hi:[1,0,1]
  v_lshlrev_b32 v4, 16, v44
  v_and_b32 v5, s68, v44
  v_pk_fma_f32 v[120:121], v[4:5], v[130:131], v[120:121] op_sel_hi:[1,0,1]
  v_lshlrev_b32 v6, 16, v45
  v_and_b32 v7, s68, v45
  v_pk_fma_f32 v[122:123], v[6:7], v[130:131], v[122:123] op_sel_hi:[1,0,1]
  v_lshlrev_b32 v4, 16, v46
  v_and_b32 v5, s68, v46
  v_pk_fma_f32 v[124:125], v[4:5], v[130:131], v[124:125] op_sel_hi:[1,0,1]
  v_lshlrev_b32 v6, 16, v47
  v_and_b32 v7, s68, v47
  v_pk_fma_f32 v[126:127], v[6:7], v[130:131], v[126:127] op_sel_hi:[1,0,1]
L_skipown2_53:
  s_cmp_eq_u32 s6, 1
  s_cbranch_scc1 L_skipown2_54
  v_lshlrev_b32 v4, 16, v48
  v_and_b32 v5, s68, v48
  v_pk_fma_f32 v[96:97], v[4:5], v[132:133], v[96:97] op_sel_hi:[1,0,1]
  v_lshlrev_b32 v6, 16, v49
  v_and_b32 v7, s68, v49
  v_pk_fma_f32 v[98:99], v[6:7], v[132:133], v[98:99] op_sel_hi:[1,0,1]
  v_lshlrev_b32 v4, 16, v50
  v_and_b32 v5, s68, v50
  v_pk_fma_f32 v[100:101], v[4:5], v[132:133], v[100:101] op_sel_hi:[1,0,1]
  v_lshlrev_b32 v6, 16, v51
  v_and_b32 v7, s68, v51
  v_pk_fma_f32 v[102:103], v[6:7], v[132:133], v[102:103] op_sel_hi:[1,0,1]
  v_lshlrev_b32 v4, 16, v52
  v_and_b32 v5, s68, v52
  v_pk_fma_f32 v[104:105], v[4:5], v[132:133], v[104:105] op_sel_hi:[1,0,1]
  v_lshlrev_b32 v6, 16, v53
  v_and_b32 v7, s68, v53
  v_pk_fma_f32 v[106:107], v[6:7], v[132:133], v[106:107] op_sel_hi:[1,0,1]
  v_lshlrev_b32 v4, 16, v54
  v_and_b32 v5, s68, v54
  v_pk_fma_f32 v[108:109], v[4:5], v[132:133], v[108:109] op_sel_hi:[1,0,1]
  v_lshlrev_b32 v6, 16, v55
  v_and_b32 v7, s68, v55
  v_pk_fma_f32 v[110:111], v[6:7], v[132:133], v[110:111] op_sel_hi:[1,0,1]
  v_lshlrev_b32 v4, 16, v56
  v_and_b32 v5, s68, v56
  v_pk_fma_f32 v[112:113], v[4:5], v[134:135], v[112:113] op_sel_hi:[1,0,1]
  v_lshlrev_b32 v6, 16, v57
  v_and_b32 v7, s68, v57
  v_pk_fma_f32 v[114:115], v[6:7], v[134:135], v[114:115] op_sel_hi:[1,0,1]
  v_lshlrev_b32 v4, 16, v58
  v_and_b32 v5, s68, v58
  v_pk_fma_f32 v[116:117], v[4:5], v[134:135], v[116:117] op_sel_hi:[1,0,1]
  v_lshlrev_b32 v6, 16, v59
  v_and_b32 v7, s68, v59
  v_pk_fma_f32 v[118:119], v[6:7], v[134:135], v[118:119] op_sel_hi:[1,0,1]
  v_lshlrev_b32 v4, 16, v60
  v_and_b32 v5, s68, v60
  v_pk_fma_f32 v[120:121], v[4:5], v[134:135], v[120:121] op_sel_hi:[1,0,1]
  v_lshlrev_b32 v6, 16, v61
  v_and_b32 v7, s68, v61
  v_pk_fma_f32 v[122:123], v[6:7], v[134:135], v[122:123] op_sel_hi:[1,0,1]
  v_lshlrev_b32 v4, 16, v62
  v_and_b32 v5, s68, v62
  v_pk_fma_f32 v[124:125], v[4:5], v[134:135], v[124:125] op_sel_hi:[1,0,1]
  v_lshlrev_b32 v6, 16, v63
  v_and_b32 v7, s68, v63
  v_pk_fma_f32 v[126:127], v[6:7], v[134:135], v[126:127] op_sel_hi:[1,0,1]
L_skipown2_54:
  s_cmp_eq_u32 s6, 2
  s_cbranch_scc1 L_skipown2_55
  v_lshlrev_b32 v4, 16, v64
  v_and_b32 v5, s68, v64
  v_pk_fma_f32 v[96:97], v[4:5], v[136:137], v[96:97] op_sel_hi:[1,0,1]
  v_lshlrev_b32 v6, 16, v65
  v_and_b32 v7, s68, v65
  v_pk_fma_f32 v[98:99], v[6:7], v[136:137], v[98:99] op_sel_hi:[1,0,1]
  v_lshlrev_b32 v4, 16, v66
  v_and_b32 v5, s68, v66
  v_pk_fma_f32 v[100:101], v[4:5], v[136:137], v[100:101] op_sel_hi:[1,0,1]
  v_lshlrev_b32 v6, 16, v67
  v_and_b32 v7, s68, v67
  v_pk_fma_f32 v[102:103], v[6:7], v[136:137], v[102:103] op_sel_hi:[1,0,1]
  v_lshlrev_b32 v4, 16, v68
  v_and_b32 v5, s68, v68
  v_pk_fma_f32 v[104:105], v[4:5], v[136:137], v[104:105] op_sel_hi:[1,0,1]
  v_lshlrev_b32 v6, 16, v69
  v_and_b32 v7, s68, v69
  v_pk_fma_f32 v[106:107], v[6:7], v[136:137], v[106:107] op_sel_hi:[1,0,1]
  v_lshlrev_b32 v4, 16, v70
  v_and_b32 v5, s68, v70
  v_pk_fma_f32 v[108:109], v[4:5], v[136:137], v[108:109] op_sel_hi:[1,0,1]
  v_lshlrev_b32 v6, 16, v71
  v_and_b32 v7, s68, v71
  v_pk_fma_f32 v[110:111], v[6:7], v[136:137], v[110:111] op_sel_hi:[1,0,1]
  v_lshlrev_b32 v4, 16, v72
  v_and_b32 v5, s68, v72
  v_pk_fma_f32 v[112:113], v[4:5], v[138:139], v[112:113] op_sel_hi:[1,0,1]
  v_lshlrev_b32 v6, 16, v73
  v_and_b32 v7, s68, v73
  v_pk_fma_f32 v[114:115], v[6:7], v[138:139], v[114:115] op_sel_hi:[1,0,1]
  v_lshlrev_b32 v4, 16, v74
  v_and_b32 v5, s68, v74
  v_pk_fma_f32 v[116:117], v[4:5], v[138:139], v[116:117] op_sel_hi:[1,0,1]
  v_lshlrev_b32 v6, 16, v75
  v_and_b32 v7, s68, v75
  v_pk_fma_f32 v[118:119], v[6:7], v[138:139], v[118:119] op_sel_hi:[1,0,1]
  v_lshlrev_b32 v4, 16, v76
  v_and_b32 v5, s68, v76
  v_pk_fma_f32 v[120:121], v[4:5], v[138:139], v[120:121] op_sel_hi:[1,0,1]
  v_lshlrev_b32 v6, 16, v77
  v_and_b32 v7, s68, v77
  v_pk_fma_f32 v[122:123], v[6:7], v[138:139], v[122:123] op_sel_hi:[1,0,1]
  v_lshlrev_b32 v4, 16, v78
  v_and_b32 v5, s68, v78
  v_pk_fma_f32 v[124:125], v[4:5], v[138:139], v[124:125] op_sel_hi:[1,0,1]
  v_lshlrev_b32 v6, 16, v79
  v_and_b32 v7, s68, v79
  v_pk_fma_f32 v[126:127], v[6:7], v[138:139], v[126:127] op_sel_hi:[1,0,1]
L_skipown2_55:
  s_cmp_eq_u32 s6, 3
  s_cbranch_scc1 L_skipown2_56
  v_lshlrev_b32 v4, 16, v80
  v_and_b32 v5, s68, v80
  v_pk_fma_f32 v[96:97], v[4:5], v[140:141], v[96:97] op_sel_hi:[1,0,1]
  v_lshlrev_b32 v6, 16, v81
  v_and_b32 v7, s68, v81
  v_pk_fma_f32 v[98:99], v[6:7], v[140:141], v[98:99] op_sel_hi:[1,0,1]
  v_lshlrev_b32 v4, 16, v82
  v_and_b32 v5, s68, v82
  v_pk_fma_f32 v[100:101], v[4:5], v[140:141], v[100:101] op_sel_hi:[1,0,1]
  v_lshlrev_b32 v6, 16, v83
  v_and_b32 v7, s68, v83
  v_pk_fma_f32 v[102:103], v[6:7], v[140:141], v[102:103] op_sel_hi:[1,0,1]
  v_lshlrev_b32 v4, 16, v84
  v_and_b32 v5, s68, v84
  v_pk_fma_f32 v[104:105], v[4:5], v[140:141], v[104:105] op_sel_hi:[1,0,1]
  v_lshlrev_b32 v6, 16, v85
  v_and_b32 v7, s68, v85
  v_pk_fma_f32 v[106:107], v[6:7], v[140:141], v[106:107] op_sel_hi:[1,0,1]
  v_lshlrev_b32 v4, 16, v86
  v_and_b32 v5, s68, v86
  v_pk_fma_f32 v[108:109], v[4:5], v[140:141], v[108:109] op_sel_hi:[1,0,1]
  v_lshlrev_b32 v6, 16, v87
  v_and_b32 v7, s68, v87
  v_pk_fma_f32 v[110:111], v[6:7], v[140:141], v[110:111] op_sel_hi:[1,0,1]
  v_lshlrev_b32 v4, 16, v88
  v_and_b32 v5, s68, v88
  v_pk_fma_f32 v[112:113], v[4:5], v[142:143], v[112:113] op_sel_hi:[1,0,1]
  v_lshlrev_b32 v6, 16, v89
  v_and_b32 v7, s68, v89
  v_pk_fma_f32 v[114:115], v[6:7], v[142:143], v[114:115] op_sel_hi:[1,0,1]
  v_lshlrev_b32 v4, 16, v90
  v_and_b32 v5, s68, v90
  v_pk_fma_f32 v[116:117], v[4:5], v[142:143], v[116:117] op_sel_hi:[1,0,1]
  v_lshlrev_b32 v6, 16, v91
  v_and_b32 v7, s68, v91
  v_pk_fma_f32 v[118:119], v[6:7], v[142:143], v[118:119] op_sel_hi:[1,0,1]
  v_lshlrev_b32 v4, 16, v92
  v_and_b32 v5, s68, v92
  v_pk_fma_f32 v[120:121], v[4:5], v[142:143], v[120:121] op_sel_hi:[1,0,1]
  v_lshlrev_b32 v6, 16, v93
  v_and_b32 v7, s68, v93
  v_pk_fma_f32 v[122:123], v[6:7], v[142:143], v[122:123] op_sel_hi:[1,0,1]
  v_lshlrev_b32 v4, 16, v94
  v_and_b32 v5, s68, v94
  v_pk_fma_f32 v[124:125], v[4:5], v[142:143], v[124:125] op_sel_hi:[1,0,1]
  v_lshlrev_b32 v6, 16, v95
  v_and_b32 v7, s68, v95
  v_pk_fma_f32 v[126:127], v[6:7], v[142:143], v[126:127] op_sel_hi:[1,0,1]
L_skipown2_56:
  v_cvt_pk_bf16_f32 v176, v96, v97
  v_cvt_pk_bf16_f32 v177, v98, v99
  v_cvt_pk_bf16_f32 v178, v100, v101
  v_cvt_pk_bf16_f32 v179, v102, v103
  v_cvt_pk_bf16_f32 v180, v104, v105
  v_cvt_pk_bf16_f32 v181, v106, v107
  v_cvt_pk_bf16_f32 v182, v108, v109
  v_cvt_pk_bf16_f32 v183, v110, v111
  v_cvt_pk_bf16_f32 v184, v112, v113
  v_cvt_pk_bf16_f32 v185, v114, v115
  v_cvt_pk_bf16_f32 v186, v116, v117
  v_cvt_pk_bf16_f32 v187, v118, v119
  v_cvt_pk_bf16_f32 v188, v120, v121
  v_cvt_pk_bf16_f32 v189, v122, v123
  v_cvt_pk_bf16_f32 v190, v124, v125
  v_cvt_pk_bf16_f32 v191, v126, v127
  s_lshl_b32 s64, s5, 5
  s_lshl_b32 s65, s4, 2
  s_add_u32 s64, s64, s65
  s_cmp_eq_u32 s9, 0
  s_cbranch_scc1 L_sg_57
  s_add_u32 s66, s75, 0
  buffer_store_dwordx4 v[176:179], v14, s[52:55], s66 offen
  s_add_u32 s66, s75, 1024
  buffer_store_dwordx4 v[180:183], v14, s[52:55], s66 offen
  s_add_u32 s66, s75, 8192
  buffer_store_dwordx4 v[184:187], v14, s[52:55], s66 offen
  s_add_u32 s66, s75, 9216
  buffer_store_dwordx4 v[188:191], v14, s[52:55], s66 offen
  s_branch L_se_58
L_sg_57:
  s_add_u32 s66, s75, 0
  buffer_store_dwordx4 v[176:179], v14, s[52:55], s66 offen sc0 sc1
  s_add_u32 s66, s75, 1024
  buffer_store_dwordx4 v[180:183], v14, s[52:55], s66 offen sc0 sc1
  s_add_u32 s66, s75, 8192
  buffer_store_dwordx4 v[184:187], v14, s[52:55], s66 offen sc0 sc1
  s_add_u32 s66, s75, 9216
  buffer_store_dwordx4 v[188:191], v14, s[52:55], s66 offen sc0 sc1
L_se_58:
  s_barrier
  v_add_u32 v8, s12, v14
  ds_write_b128 v8, v[176:179] offset:0
  ds_write_b128 v8, v[180:183] offset:1024
  ds_write_b128 v8, v[184:187] offset:8192
  ds_write_b128 v8, v[188:191] offset:9216
  s_lshl_b32 s66, s11, 7
  s_lshl_b32 s67, s6, 4
  s_add_u32 s67, s67, s66
  s_lshl_b32 s68, s3, 2
  s_add_u32 s67, s67, s68
  s_add_u32 s67, s67, 34668544
  s_waitcnt vmcnt(0)
  v_mov_b32 v4, s8
  v_mov_b32 v5, 0
  s_mov_b64 exec, 1
  s_cmp_eq_u32 s9, 0
  s_cbranch_scc1 L_fg_59
  buffer_store_dword v4, v5, s[52:55], s67 offen
  s_branch L_fe_60
L_fg_59:
  buffer_store_dword v4, v5, s[52:55], s67 offen sc0 sc1
L_fe_60:
  s_mov_b64 exec, -1
  s_waitcnt lgkmcnt(0)
  s_barrier
  ds_read_b128 v[32:35], v14 offset:0
  ds_read_b128 v[36:39], v14 offset:8192
  ds_read_b128 v[40:43], v14 offset:1024
  ds_read_b128 v[44:47], v14 offset:9216
  ds_read_b128 v[48:51], v14 offset:2048
  ds_read_b128 v[52:55], v14 offset:10240
  ds_read_b128 v[56:59], v14 offset:3072
  ds_read_b128 v[60:63], v14 offset:11264
  ds_read_b128 v[64:67], v14 offset:4096
  ds_read_b128 v[68:71], v14 offset:12288
  ds_read_b128 v[72:75], v14 offset:5120
  ds_read_b128 v[76:79], v14 offset:13312
  s_waitcnt lgkmcnt(10)
  v_mfma_f32_32x32x16_bf16 v[128:143], a[128:131], v[32:35], 0
  v_mfma_f32_32x32x16_bf16 v[144:159], a[128:131], v[36:39], 0
  ds_read_b128 v[32:35], v14 offset:6144
  ds_read_b128 v[36:39], v14 offset:14336
  s_waitcnt lgkmcnt(10)
  v_mfma_f32_32x32x16_bf16 v[128:143], a[132:135], v[40:43], v[128:143]
  v_mfma_f32_32x32x16_bf16 v[144:159], a[132:135], v[44:47], v[144:159]
  ds_read_b128 v[40:43], v14 offset:7168
  ds_read_b128 v[44:47], v14 offset:15360
  s_waitcnt lgkmcnt(10)
  v_mfma_f32_32x32x16_bf16 v[128:143], a[136:139], v[48:51], v[128:143]
  v_mfma_f32_32x32x16_bf16 v[144:159], a[136:139], v[52:55], v[144:159]
  s_waitcnt lgkmcnt(8)
  v_mfma_f32_32x32x16_bf16 v[128:143], a[140:143], v[56:59], v[128:143]
  v_mfma_f32_32x32x16_bf16 v[144:159], a[140:143], v[60:63], v[144:159]
  s_waitcnt lgkmcnt(6)
  v_mfma_f32_32x32x16_bf16 v[128:143], a[144:147], v[64:67], v[128:143]
  v_mfma_f32_32x32x16_bf16 v[144:159], a[144:147], v[68:71], v[144:159]
  s_waitcnt lgkmcnt(4)
  v_mfma_f32_32x32x16_bf16 v[128:143], a[148:151], v[72:75], v[128:143]
  v_mfma_f32_32x32x16_bf16 v[144:159], a[148:151], v[76:79], v[144:159]
  s_waitcnt lgkmcnt(2)
  v_mfma_f32_32x32x16_bf16 v[128:143], a[152:155], v[32:35], v[128:143]
  v_mfma_f32_32x32x16_bf16 v[144:159], a[152:155], v[36:39], v[144:159]
  s_waitcnt lgkmcnt(0)
  v_mfma_f32_32x32x16_bf16 v[128:143], a[156:159], v[40:43], v[128:143]
  v_mfma_f32_32x32x16_bf16 v[144:159], a[156:159], v[44:47], v[144:159]
  s_add_u32 s67, s66, 34668544
  s_mov_b32 s14, 65536
L_poll_61:
  buffer_load_dword v4, v15, s[52:55], s67 offen sc1
  s_sub_u32 s14, s14, 1
  s_cbranch_scc1 L_pollx_62
  s_waitcnt vmcnt(0)
  v_cmp_ne_u32 vcc, s8, v4
  s_nop 4
  s_and_b32 s79, vcc_lo, 0xffff
  s_cbranch_scc1 L_poll_61
L_pollx_62:
  s_lshl_b32 s66, s3, 12
  s_add_u32 s65, s6, 1
  s_and_b32 s65, s65, 3
  s_add_u32 s65, s65, s64
  s_lshl_b32 s65, s65, 14
  s_add_u32 s65, s65, s66
  s_add_u32 m0, s66, 16384
  s_add_u32 s67, s65, 0
  buffer_load_dwordx4 v14, s[52:55], s67 offen sc1 lds
  s_add_u32 m0, s66, 17408
  s_add_u32 s67, s65, 1024
  buffer_load_dwordx4 v14, s[52:55], s67 offen sc1 lds
  s_add_u32 m0, s66, 18432
  s_add_u32 s67, s65, 2048
  buffer_load_dwordx4 v14, s[52:55], s67 offen sc1 lds
  s_add_u32 m0, s66, 19456
  s_add_u32 s67, s65, 3072
  buffer_load_dwordx4 v14, s[52:55], s67 offen sc1 lds
  s_add_u32 s65, s6, 2
  s_and_b32 s65, s65, 3
  s_add_u32 s65, s65, s64
  s_lshl_b32 s65, s65, 14
  s_add_u32 s65, s65, s66
  s_add_u32 m0, s66, 32768
  s_add_u32 s67, s65, 0
  buffer_load_dwordx4 v14, s[52:55], s67 offen sc1 lds
  s_add_u32 m0, s66, 33792
  s_add_u32 s67, s65, 1024
  buffer_load_dwordx4 v14, s[52:55], s67 offen sc1 lds
  s_add_u32 m0, s66, 34816
  s_add_u32 s67, s65, 2048
  buffer_load_dwordx4 v14, s[52:55], s67 offen sc1 lds
  s_add_u32 m0, s66, 35840
  s_add_u32 s67, s65, 3072
  buffer_load_dwordx4 v14, s[52:55], s67 offen sc1 lds
  s_add_u32 s65, s6, 3
  s_and_b32 s65, s65, 3
  s_add_u32 s65, s65, s64
  s_lshl_b32 s65, s65, 14
  s_add_u32 s65, s65, s66
  s_add_u32 m0, s66, 49152
  s_add_u32 s67, s65, 0
  buffer_load_dwordx4 v14, s[52:55], s67 offen sc1 lds
  s_add_u32 m0, s66, 50176
  s_add_u32 s67, s65, 1024
  buffer_load_dwordx4 v14, s[52:55], s67 offen sc1 lds
  s_add_u32 m0, s66, 51200
  s_add_u32 s67, s65, 2048
  buffer_load_dwordx4 v14, s[52:55], s67 offen sc1 lds
  s_add_u32 m0, s66, 52224
  s_add_u32 s67, s65, 3072
  buffer_load_dwordx4 v14, s[52:55], s67 offen sc1 lds
  s_waitcnt vmcnt(0)
  s_barrier
  s_lshl_b32 s64, s5, 2
  s_add_u32 s64, s64, s6
  s_lshl_b32 s65, s64, 3
  s_add_u32 s65, s65, s4
  s_lshl_b32 s65, s65, 15
  s_lshl_b32 s66, s3, 13
  s_add_u32 s65, s65, s66
  ds_read_b128 v[32:35], v14 offset:16384
  ds_read_b128 v[36:39], v14 offset:17408
  ds_read_b128 v[40:43], v14 offset:18432
  ds_read_b128 v[44:47], v14 offset:19456
  ds_read_b128 v[48:51], v14 offset:20480
  ds_read_b128 v[52:55], v14 offset:21504
  ds_read_b128 v[56:59], v14 offset:22528
  ds_read_b128 v[60:63], v14 offset:23552
  ds_read_b128 v[64:67], v14 offset:32768
  ds_read_b128 v[68:71], v14 offset:33792
  ds_read_b128 v[72:75], v14 offset:34816
  ds_read_b128 v[76:79], v14 offset:35840
  s_waitcnt lgkmcnt(11)
  v_mfma_f32_32x32x16_bf16 v[128:143], a[160:163], v[32:35], v[128:143]
  ds_read_b128 v[32:35], v14 offset:36864
  s_waitcnt lgkmcnt(11)
  v_mfma_f32_32x32x16_bf16 v[128:143], a[164:167], v[36:39], v[128:143]
  ds_read_b128 v[36:39], v14 offset:37888
  s_waitcnt lgkmcnt(11)
  v_mfma_f32_32x32x16_bf16 v[128:143], a[168:171], v[40:43], v[128:143]
  ds_read_b128 v[40:43], v14 offset:38912
  s_waitcnt lgkmcnt(11)
  v_mfma_f32_32x32x16_bf16 v[128:143], a[172:175], v[44:47], v[128:143]
  ds_read_b128 v[44:47], v14 offset:39936
  s_waitcnt lgkmcnt(11)
  v_mfma_f32_32x32x16_bf16 v[128:143], a[176:179], v[48:51], v[128:143]
  ds_read_b128 v[48:51], v14 offset:49152
  s_waitcnt lgkmcnt(11)
  v_mfma_f32_32x32x16_bf16 v[128:143], a[180:183], v[52:55], v[128:143]
  ds_read_b128 v[52:55], v14 offset:50176
  s_waitcnt lgkmcnt(11)
  v_mfma_f32_32x32x16_bf16 v[128:143], a[184:187], v[56:59], v[128:143]
  ds_read_b128 v[56:59], v14 offset:51200
  s_waitcnt lgkmcnt(11)
  v_mfma_f32_32x32x16_bf16 v[128:143], a[188:191], v[60:63], v[128:143]
  ds_read_b128 v[60:63], v14 offset:52224
  s_waitcnt lgkmcnt(11)
  v_mfma_f32_32x32x16_bf16 v[128:143], a[192:195], v[64:67], v[128:143]
  ds_read_b128 v[64:67], v14 offset:53248
  s_waitcnt lgkmcnt(11)
  v_mfma_f32_32x32x16_bf16 v[128:143], a[196:199], v[68:71], v[128:143]
  ds_read_b128 v[68:71], v14 offset:54272
  s_waitcnt lgkmcnt(11)
  v_mfma_f32_32x32x16_bf16 v[128:143], a[200:203], v[72:75], v[128:143]
  ds_read_b128 v[72:75], v14 offset:55296
  s_waitcnt lgkmcnt(11)
  v_mfma_f32_32x32x16_bf16 v[128:143], a[204:207], v[76:79], v[128:143]
  ds_read_b128 v[76:79], v14 offset:56320
  s_waitcnt lgkmcnt(11)
  v_mfma_f32_32x32x16_bf16 v[128:143], a[208:211], v[32:35], v[128:143]
  ds_read_b128 v[32:35], v14 offset:24576
  s_waitcnt lgkmcnt(11)
  v_mfma_f32_32x32x16_bf16 v[128:143], a[212:215], v[36:39], v[128:143]
  ds_read_b128 v[36:39], v14 offset:25600
  s_waitcnt lgkmcnt(11)
  v_mfma_f32_32x32x16_bf16 v[128:143], a[216:219], v[40:43], v[128:143]
  ds_read_b128 v[40:43], v14 offset:26624
  s_waitcnt lgkmcnt(11)
  v_mfma_f32_32x32x16_bf16 v[128:143], a[220:223], v[44:47], v[128:143]
  ds_read_b128 v[44:47], v14 offset:27648
  s_waitcnt lgkmcnt(11)
  v_mfma_f32_32x32x16_bf16 v[128:143], a[224:227], v[48:51], v[128:143]
  ds_read_b128 v[48:51], v14 offset:28672
  s_waitcnt lgkmcnt(11)
  v_mfma_f32_32x32x16_bf16 v[128:143], a[228:231], v[52:55], v[128:143]
  ds_read_b128 v[52:55], v14 offset:29696
  s_waitcnt lgkmcnt(11)
  v_mfma_f32_32x32x16_bf16 v[128:143], a[232:235], v[56:59], v[128:143]
  ds_read_b128 v[56:59], v14 offset:30720
  s_waitcnt lgkmcnt(11)
  v_mfma_f32_32x32x16_bf16 v[128:143], a[236:239], v[60:63], v[128:143]
  ds_read_b128 v[60:63], v14 offset:31744
  s_waitcnt lgkmcnt(11)
  v_mfma_f32_32x32x16_bf16 v[128:143], a[240:243], v[64:67], v[128:143]
  ds_read_b128 v[64:67], v14 offset:40960
  s_waitcnt lgkmcnt(11)
  v_mfma_f32_32x32x16_bf16 v[128:143], a[244:247], v[68:71], v[128:143]
  ds_read_b128 v[68:71], v14 offset:41984
  s_waitcnt lgkmcnt(11)
  v_mfma_f32_32x32x16_bf16 v[128:143], a[248:251], v[72:75], v[128:143]
  ds_read_b128 v[72:75], v14 offset:43008
  s_waitcnt lgkmcnt(11)
  v_mfma_f32_32x32x16_bf16 v[128:143], a[252:255], v[76:79], v[128:143]
  ds_read_b128 v[76:79], v14 offset:44032
  s_waitcnt lgkmcnt(11)
  v_mfma_f32_32x32x16_bf16 v[144:159], a[160:163], v[32:35], v[144:159]
  ds_read_b128 v[32:35], v14 offset:45056
  s_waitcnt lgkmcnt(11)
  v_mfma_f32_32x32x16_bf16 v[144:159], a[164:167], v[36:39], v[144:159]
  ds_read_b128 v[36:39], v14 offset:46080
  s_waitcnt lgkmcnt(11)
  v_mfma_f32_32x32x16_bf16 v[144:159], a[168:171], v[40:43], v[144:159]
  ds_read_b128 v[40:43], v14 offset:47104
  s_waitcnt lgkmcnt(11)
  v_mfma_f32_32x32x16_bf16 v[144:159], a[172:175], v[44:47], v[144:159]
  ds_read_b128 v[44:47], v14 offset:48128
  s_waitcnt lgkmcnt(11)
  v_mfma_f32_32x32x16_bf16 v[144:159], a[176:179], v[48:51], v[144:159]
  ds_read_b128 v[48:51], v14 offset:57344
  s_waitcnt lgkmcnt(11)
  v_mfma_f32_32x32x16_bf16 v[144:159], a[180:183], v[52:55], v[144:159]
  ds_read_b128 v[52:55], v14 offset:58368
  s_waitcnt lgkmcnt(11)
  v_mfma_f32_32x32x16_bf16 v[144:159], a[184:187], v[56:59], v[144:159]
  s_add_u32 s66, s65, 26214400
  buffer_store_dwordx4 v[128:131], v14, s[52:55], s66 offen offset:0 sc0 sc1
  ds_read_b128 v[56:59], v14 offset:59392
  s_waitcnt lgkmcnt(11)
  v_mfma_f32_32x32x16_bf16 v[144:159], a[188:191], v[60:63], v[144:159]
  buffer_store_dwordx4 v[132:135], v14, s[52:55], s66 offen offset:1024 sc0 sc1
  ds_read_b128 v[60:63], v14 offset:60416
  s_waitcnt lgkmcnt(11)
  v_mfma_f32_32x32x16_bf16 v[144:159], a[192:195], v[64:67], v[144:159]
  buffer_store_dwordx4 v[136:139], v14, s[52:55], s66 offen offset:2048 sc0 sc1
  ds_read_b128 v[64:67], v14 offset:61440
  s_waitcnt lgkmcnt(11)
  v_mfma_f32_32x32x16_bf16 v[144:159], a[196:199], v[68:71], v[144:159]
  buffer_store_dwordx4 v[140:143], v14, s[52:55], s66 offen offset:3072 sc0 sc1
  ds_read_b128 v[68:71], v14 offset:62464
  s_waitcnt lgkmcnt(11)
  v_mfma_f32_32x32x16_bf16 v[144:159], a[200:203], v[72:75], v[144:159]
  ds_read_b128 v[72:75], v14 offset:63488
  s_waitcnt lgkmcnt(11)
  v_mfma_f32_32x32x16_bf16 v[144:159], a[204:207], v[76:79], v[144:159]
  ds_read_b128 v[76:79], v14 offset:64512
  s_waitcnt lgkmcnt(11)
  v_mfma_f32_32x32x16_bf16 v[144:159], a[208:211], v[32:35], v[144:159]
  s_waitcnt lgkmcnt(10)
  v_mfma_f32_32x32x16_bf16 v[144:159], a[212:215], v[36:39], v[144:159]
  s_waitcnt lgkmcnt(9)
  v_mfma_f32_32x32x16_bf16 v[144:159], a[216:219], v[40:43], v[144:159]
  s_waitcnt lgkmcnt(8)
  v_mfma_f32_32x32x16_bf16 v[144:159], a[220:223], v[44:47], v[144:159]
  s_waitcnt lgkmcnt(7)
  v_mfma_f32_32x32x16_bf16 v[144:159], a[224:227], v[48:51], v[144:159]
  s_waitcnt lgkmcnt(6)
  v_mfma_f32_32x32x16_bf16 v[144:159], a[228:231], v[52:55], v[144:159]
  s_waitcnt lgkmcnt(5)
  v_mfma_f32_32x32x16_bf16 v[144:159], a[232:235], v[56:59], v[144:159]
  s_waitcnt lgkmcnt(4)
  v_mfma_f32_32x32x16_bf16 v[144:159], a[236:239], v[60:63], v[144:159]
  s_waitcnt lgkmcnt(3)
  v_mfma_f32_32x32x16_bf16 v[144:159], a[240:243], v[64:67], v[144:159]
  s_waitcnt lgkmcnt(2)
  v_mfma_f32_32x32x16_bf16 v[144:159], a[244:247], v[68:71], v[144:159]
  s_waitcnt lgkmcnt(1)
  v_mfma_f32_32x32x16_bf16 v[144:159], a[248:251], v[72:75], v[144:159]
  s_waitcnt lgkmcnt(0)
  v_mfma_f32_32x32x16_bf16 v[144:159], a[252:255], v[76:79], v[144:159]
  s_nop 11
  s_add_u32 s66, s65, 26218496
  buffer_store_dwordx4 v[144:147], v14, s[52:55], s66 offen offset:0 sc0 sc1
  buffer_store_dwordx4 v[148:151], v14, s[52:55], s66 offen offset:1024 sc0 sc1
  buffer_store_dwordx4 v[152:155], v14, s[52:55], s66 offen offset:2048 sc0 sc1
  buffer_store_dwordx4 v[156:159], v14, s[52:55], s66 offen offset:3072 sc0 sc1
  s_waitcnt vmcnt(0)
  s_lshl_b32 s66, s64, 9
  s_lshl_b32 s67, s3, 7
  s_add_u32 s67, s67, s66
  s_lshl_b32 s68, s4, 2
  s_add_u32 s67, s67, s68
  s_add_u32 s67, s67, 34684928
  v_mov_b32 v4, s8
  v_mov_b32 v5, 0
  s_mov_b64 exec, 1
  buffer_store_dword v4, v5, s[52:55], s67 offen sc0 sc1
  s_mov_b64 exec, -1
  s_cmp_ge_u32 s3, 2
  s_cbranch_scc1 L_p5done
  s_lshr_b32 s67, s4, 1
  s_lshl_b32 s67, s67, 7
  s_add_u32 s67, s67, s66
  s_add_u32 s67, s67, 34684928
  s_lshl_b32 s64, s64, 18
  s_lshr_b32 s65, s4, 1
  s_lshl_b32 s65, s65, 13
  s_add_u32 s64, s64, s65
  s_and_b32 s65, s4, 1
  s_lshl_b32 s65, s65, 12
  s_add_u32 s64, s64, s65
  s_lshl_b32 s66, s3, 11
  s_add_u32 s64, s64, s66
  s_mov_b32 s69, 0
  s_mov_b32 s14, 65536
L_p5_63:
  buffer_load_dword v4, v15, s[52:55], s67 offen sc1
  s_sub_u32 s14, s14, 1
  s_cbranch_scc1 L_p5x_64
  s_waitcnt vmcnt(0)
  v_cmp_eq_u32 vcc, s8, v4
  s_nop 4
  s_andn2_b32 s70, vcc_lo, s69
  s_and_b32 s70, s70, 0xff
  s_or_b32 s69, s69, s70
  s_bitcmp1_b32 s70, 0
  s_cbranch_scc0 L_p5s_65
  s_add_u32 s66, s64, 26214400
  buffer_load_dwordx4 v[32:35], v14, s[52:55], s66 offen sc1
  buffer_load_dwordx4 v[36:39], v14, s[52:55], s66 offen offset:1024 sc1
L_p5s_65:
  s_bitcmp1_b32 s70, 1
  s_cbranch_scc0 L_p5s_66
  s_add_u32 s66, s64, 26247168
  buffer_load_dwordx4 v[40:43], v14, s[52:55], s66 offen sc1
  buffer_load_dwordx4 v[44:47], v14, s[52:55], s66 offen offset:1024 sc1
L_p5s_66:
  s_bitcmp1_b32 s70, 2
  s_cbranch_scc0 L_p5s_67
  s_add_u32 s66, s64, 26279936
  buffer_load_dwordx4 v[48:51], v14, s[52:55], s66 offen sc1
  buffer_load_dwordx4 v[52:55], v14, s[52:55], s66 offen offset:1024 sc1
L_p5s_67:
  s_bitcmp1_b32 s70, 3
  s_cbranch_scc0 L_p5s_68
  s_add_u32 s66, s64, 26312704
  buffer_load_dwordx4 v[56:59], v14, s[52:55], s66 offen sc1
  buffer_load_dwordx4 v[60:63], v14, s[52:55], s66 offen offset:1024 sc1
L_p5s_68:
  s_bitcmp1_b32 s70, 4
  s_cbranch_scc0 L_p5s_69
  s_add_u32 s66, s64, 26345472
  buffer_load_dwordx4 v[64:67], v14, s[52:55], s66 offen sc1
  buffer_load_dwordx4 v[68:71], v14, s[52:55], s66 offen offset:1024 sc1
L_p5s_69:
  s_bitcmp1_b32 s70, 5
  s_cbranch_scc0 L_p5s_70
  s_add_u32 s66, s64, 26378240
  buffer_load_dwordx4 v[72:75], v14, s[52:55], s66 offen sc1
  buffer_load_dwordx4 v[76:79], v14, s[52:55], s66 offen offset:1024 sc1
L_p5s_70:
  s_bitcmp1_b32 s70, 6
  s_cbranch_scc0 L_p5s_71
  s_add_u32 s66, s64, 26411008
  buffer_load_dwordx4 v[80:83], v14, s[52:55], s66 offen sc1
  buffer_load_dwordx4 v[84:87], v14, s[52:55], s66 offen offset:1024 sc1
L_p5s_71:
  s_bitcmp1_b32 s70, 7
  s_cbranch_scc0 L_p5s_72
  s_add_u32 s66, s64, 26443776
  buffer_load_dwordx4 v[88:91], v14, s[52:55], s66 offen sc1
  buffer_load_dwordx4 v[92:95], v14, s[52:55], s66 offen offset:1024 sc1
L_p5s_72:
  s_cmp_lg_u32 s69, 0xff
  s_cbranch_scc1 L_p5_63
L_p5x_64:
  s_mov_b32 s56, s26
  s_mov_b32 s57, s27
  s_mov_b32 s58, 0x80000
  s_mov_b32 s59, 0x20000
  s_lshl_b32 s67, s5, 6
  s_and_b32 s68, s4, 1
  s_lshl_b32 s68, s68, 5
  s_add_u32 s67, s67, s68
  s_lshl_b32 s67, s67, 10
  s_lshl_b32 s68, s6, 7
  s_lshr_b32 s69, s4, 1
  s_lshl_b32 s69, s69, 5
  s_add_u32 s68, s68, s69
  s_lshl_b32 s69, s3, 4
  s_add_u32 s68, s68, s69
  s_lshl_b32 s68, s68, 1
  s_add_u32 s67, s67, s68
  v_and_b32 v2, 31, v0
  v_lshrrev_b32 v3, 5, v0
  v_lshlrev_b32 v2, 10, v2
  v_lshl_add_u32 v2, v3, 4, v2
  s_mov_b32 s68, 0xffff0000
  s_waitcnt vmcnt(0)
  v_add_f32 v32, v32, v40
  v_add_f32 v33, v33, v41
  v_add_f32 v34, v34, v42
  v_add_f32 v35, v35, v43
  v_add_f32 v36, v36, v44
  v_add_f32 v37, v37, v45
  v_add_f32 v38, v38, v46
  v_add_f32 v39, v39, v47
  v_add_f32 v32, v32, v48
  v_add_f32 v33, v33, v49
  v_add_f32 v34, v34, v50
  v_add_f32 v35, v35, v51
  v_add_f32 v36, v36, v52
  v_add_f32 v37, v37, v53
  v_add_f32 v38, v38, v54
  v_add_f32 v39, v39, v55
  v_add_f32 v32, v32, v56
  v_add_f32 v33, v33, v57
  v_add_f32 v34, v34, v58
  v_add_f32 v35, v35, v59
  v_add_f32 v36, v36, v60
  v_add_f32 v37, v37, v61
  v_add_f32 v38, v38, v62
  v_add_f32 v39, v39, v63
  v_add_f32 v32, v32, v64
  v_add_f32 v33, v33, v65
  v_add_f32 v34, v34, v66
  v_add_f32 v35, v35, v67
  v_add_f32 v36, v36, v68
  v_add_f32 v37, v37, v69
  v_add_f32 v38, v38, v70
  v_add_f32 v39, v39, v71
  v_add_f32 v32, v32, v72
  v_add_f32 v33, v33, v73
  v_add_f32 v34, v34, v74
  v_add_f32 v35, v35, v75
  v_add_f32 v36, v36, v76
  v_add_f32 v37, v37, v77
  v_add_f32 v38, v38, v78
  v_add_f32 v39, v39, v79
  v_add_f32 v32, v32, v80
  v_add_f32 v33, v33, v81
  v_add_f32 v34, v34, v82
  v_add_f32 v35, v35, v83
  v_add_f32 v36, v36, v84
  v_add_f32 v37, v37, v85
  v_add_f32 v38, v38, v86
  v_add_f32 v39, v39, v87
  v_add_f32 v32, v32, v88
  v_add_f32 v33, v33, v89
  v_add_f32 v34, v34, v90
  v_add_f32 v35, v35, v91
  v_add_f32 v36, v36, v92
  v_add_f32 v37, v37, v93
  v_add_f32 v38, v38, v94
  v_add_f32 v39, v39, v95
  v_cvt_pk_bf16_f32 v4, v32, v33
  v_cvt_pk_bf16_f32 v5, v34, v35
  v_cvt_pk_bf16_f32 v6, v36, v37
  v_cvt_pk_bf16_f32 v7, v38, v39
  s_nop 1
  buffer_store_dwordx4 v[4:7], v2, s[56:59], s67 offen
L_p5done:
L_done:
  s_endpgm
L_safe:
  s_waitcnt vmcnt(0)
  s_barrier
  v_add_u32 v224, 0x1c000, v16
  v_add_u32 v225, 0x1c000, v17
  v_add_u32 v226, 0x1c000, v18
  v_add_u32 v227, 0x1c000, v19
  v_add_u32 v228, 0x1c000, v20
  v_add_u32 v229, 0x1c000, v21
  v_add_u32 v230, 0x1c000, v22
  v_add_u32 v231, 0x1c000, v23
  v_mov_b32 v30, 0xff800000
  v_mov_b32 v28, 0
  v_mov_b32 v31, 0xff800000
  v_mov_b32 v29, 0
  v_mov_b32 v160, 0
  v_accvgpr_write_b32 a0, 0
  v_mov_b32 v161, 0
  v_accvgpr_write_b32 a1, 0
  v_mov_b32 v162, 0
  v_accvgpr_write_b32 a2, 0
  v_mov_b32 v163, 0
  v_accvgpr_write_b32 a3, 0
  v_mov_b32 v164, 0
  v_accvgpr_write_b32 a4, 0
  v_mov_b32 v165, 0
  v_accvgpr_write_b32 a5, 0
  v_mov_b32 v166, 0
  v_accvgpr_write_b32 a6, 0
  v_mov_b32 v167, 0
  v_accvgpr_write_b32 a7, 0
  v_mov_b32 v168, 0
  v_accvgpr_write_b32 a8, 0
  v_mov_b32 v169, 0
  v_accvgpr_write_b32 a9, 0
  v_mov_b32 v170, 0
  v_accvgpr_write_b32 a10, 0
  v_mov_b32 v171, 0
  v_accvgpr_write_b32 a11, 0
  v_mov_b32 v172, 0
  v_accvgpr_write_b32 a12, 0
  v_mov_b32 v173, 0
  v_accvgpr_write_b32 a13, 0
  v_mov_b32 v174, 0
  v_accvgpr_write_b32 a14, 0
  v_mov_b32 v175, 0
  v_accvgpr_write_b32 a15, 0
  v_mov_b32 v176, 0
  v_accvgpr_write_b32 a16, 0
  v_mov_b32 v177, 0
  v_accvgpr_write_b32 a17, 0
  v_mov_b32 v178, 0
  v_accvgpr_write_b32 a18, 0
  v_mov_b32 v179, 0
  v_accvgpr_write_b32 a19, 0
  v_mov_b32 v180, 0
  v_accvgpr_write_b32 a20, 0
  v_mov_b32 v181, 0
  v_accvgpr_write_b32 a21, 0
  v_mov_b32 v182, 0
  v_accvgpr_write_b32 a22, 0
  v_mov_b32 v183, 0
  v_accvgpr_write_b32 a23, 0
  v_mov_b32 v184, 0
  v_accvgpr_write_b32 a24, 0
  v_mov_b32 v185, 0
  v_accvgpr_write_b32 a25, 0
  v_mov_b32 v186, 0
  v_accvgpr_write_b32 a26, 0
  v_mov_b32 v187, 0
  v_accvgpr_write_b32 a27, 0
  v_mov_b32 v188, 0
  v_accvgpr_write_b32 a28, 0
  v_mov_b32 v189, 0
  v_accvgpr_write_b32 a29, 0
  v_mov_b32 v190, 0
  v_accvgpr_write_b32 a30, 0
  v_mov_b32 v191, 0
  v_accvgpr_write_b32 a31, 0
  v_mov_b32 v192, 0
  v_accvgpr_write_b32 a32, 0
  v_mov_b32 v193, 0
  v_accvgpr_write_b32 a33, 0
  v_mov_b32 v194, 0
  v_accvgpr_write_b32 a34, 0
  v_mov_b32 v195, 0
  v_accvgpr_write_b32 a35, 0
  v_mov_b32 v196, 0
  v_accvgpr_write_b32 a36, 0
  v_mov_b32 v197, 0
  v_accvgpr_write_b32 a37, 0
  v_mov_b32 v198, 0
  v_accvgpr_write_b32 a38, 0
  v_mov_b32 v199, 0
  v_accvgpr_write_b32 a39, 0
  v_mov_b32 v200, 0
  v_accvgpr_write_b32 a40, 0
  v_mov_b32 v201, 0
  v_accvgpr_write_b32 a41, 0
  v_mov_b32 v202, 0
  v_accvgpr_write_b32 a42, 0
  v_mov_b32 v203, 0
  v_accvgpr_write_b32 a43, 0
  v_mov_b32 v204, 0
  v_accvgpr_write_b32 a44, 0
  v_mov_b32 v205, 0
  v_accvgpr_write_b32 a45, 0
  v_mov_b32 v206, 0
  v_accvgpr_write_b32 a46, 0
  v_mov_b32 v207, 0
  v_accvgpr_write_b32 a47, 0
  v_mov_b32 v208, 0
  v_accvgpr_write_b32 a48, 0
  v_mov_b32 v209, 0
  v_accvgpr_write_b32 a49, 0
  v_mov_b32 v210, 0
  v_accvgpr_write_b32 a50, 0
  v_mov_b32 v211, 0
  v_accvgpr_write_b32 a51, 0
  v_mov_b32 v212, 0
  v_accvgpr_write_b32 a52, 0
  v_mov_b32 v213, 0
  v_accvgpr_write_b32 a53, 0
  v_mov_b32 v214, 0
  v_accvgpr_write_b32 a54, 0
  v_mov_b32 v215, 0
  v_accvgpr_write_b32 a55, 0
  v_mov_b32 v216, 0
  v_accvgpr_write_b32 a56, 0
  v_mov_b32 v217, 0
  v_accvgpr_write_b32 a57, 0
  v_mov_b32 v218, 0
  v_accvgpr_write_b32 a58, 0
  v_mov_b32 v219, 0
  v_accvgpr_write_b32 a59, 0
  v_mov_b32 v220, 0
  v_accvgpr_write_b32 a60, 0
  v_mov_b32 v221, 0
  v_accvgpr_write_b32 a61, 0
  v_mov_b32 v222, 0
  v_accvgpr_write_b32 a62, 0
  v_mov_b32 v223, 0
  v_accvgpr_write_b32 a63, 0
  s_mov_b32 s7, 0
L_safe_loop:
  s_add_u32 m0, s12, 114688
  s_nop 0
  buffer_load_dwordx4 v10, s[32:35], s7 offen offset:0 lds
  buffer_load_dwordx4 v11, s[32:35], s7 offen offset:1024 lds
  s_add_u32 m0, s12, 122880
  s_nop 0
  buffer_load_dwordx4 v12, s[36:39], s7 offen offset:0 lds
  buffer_load_dwordx4 v12, s[36:39], s7 offen offset:1024 lds
  s_waitcnt vmcnt(0)
  s_barrier
  ds_read_b128 a[192:195], v224
  ds_read_b128 a[196:199], v225
  ds_read_b128 a[200:203], v226
  ds_read_b128 a[204:207], v227
  ds_read_b128 a[208:211], v228
  ds_read_b128 a[212:215], v229
  ds_read_b128 a[216:219], v230
  ds_read_b128 a[220:223], v231
  ds_read_b64_tr_b16 a[224:225], v24 offset:57344
  ds_read_b64_tr_b16 a[226:227], v24 offset:59392
  ds_read_b64_tr_b16 a[232:233], v25 offset:57344
  ds_read_b64_tr_b16 a[234:235], v25 offset:59392
  ds_read_b64_tr_b16 a[240:241], v26 offset:57344
  ds_read_b64_tr_b16 a[242:243], v26 offset:59392
  ds_read_b64_tr_b16 a[248:249], v27 offset:57344
  ds_read_b64_tr_b16 a[250:251], v27 offset:59392
  ds_read_b64_tr_b16 a[228:229], v24 offset:61440
  ds_read_b64_tr_b16 a[230:231], v24 offset:63488
  ds_read_b64_tr_b16 a[236:237], v25 offset:61440
  ds_read_b64_tr_b16 a[238:239], v25 offset:63488
  ds_read_b64_tr_b16 a[244:245], v26 offset:61440
  ds_read_b64_tr_b16 a[246:247], v26 offset:63488
  ds_read_b64_tr_b16 a[252:253], v27 offset:61440
  ds_read_b64_tr_b16 a[254:255], v27 offset:63488
  s_waitcnt lgkmcnt(0)
  s_barrier
  v_mfma_f32_32x32x16_bf16 v[32:47], a[192:195], a[128:131], 0
  v_mfma_f32_32x32x16_bf16 v[32:47], a[196:199], a[132:135], v[32:47]
  v_mfma_f32_32x32x16_bf16 v[32:47], a[200:203], a[136:139], v[32:47]
  v_mfma_f32_32x32x16_bf16 v[32:47], a[204:207], a[140:143], v[32:47]
  v_mfma_f32_32x32x16_bf16 v[32:47], a[208:211], a[144:147], v[32:47]
  v_mfma_f32_32x32x16_bf16 v[32:47], a[212:215], a[148:151], v[32:47]
  v_mfma_f32_32x32x16_bf16 v[32:47], a[216:219], a[152:155], v[32:47]
  v_mfma_f32_32x32x16_bf16 v[32:47], a[220:223], a[156:159], v[32:47]
  v_mfma_f32_32x32x16_bf16 v[48:63], a[192:195], a[160:163], 0
  v_mfma_f32_32x32x16_bf16 v[48:63], a[196:199], a[164:167], v[48:63]
  v_mfma_f32_32x32x16_bf16 v[48:63], a[200:203], a[168:171], v[48:63]
  v_mfma_f32_32x32x16_bf16 v[48:63], a[204:207], a[172:175], v[48:63]
  v_mfma_f32_32x32x16_bf16 v[48:63], a[208:211], a[176:179], v[48:63]
  v_mfma_f32_32x32x16_bf16 v[48:63], a[212:215], a[180:183], v[48:63]
  v_mfma_f32_32x32x16_bf16 v[48:63], a[216:219], a[184:187], v[48:63]
  v_mfma_f32_32x32x16_bf16 v[48:63], a[220:223], a[188:191], v[48:63]
  s_nop 15
  v_max3_f32 v4, v32, v33, v34
  v_max3_f32 v4, v4, v35, v36
  v_max3_f32 v4, v4, v37, v38
  v_max3_f32 v4, v4, v39, v40
  v_max3_f32 v4, v4, v41, v42
  v_max3_f32 v4, v4, v43, v44
  v_max3_f32 v4, v4, v45, v46
  v_max_f32 v4, v4, v47
  v_mov_b32 v5, v4
  s_nop 1
  v_permlane32_swap_b32 v4, v5
  s_nop 1
  v_max3_f32 v4, v4, v5, v30
  v_sub_f32 v5, v30, v4
  v_exp_f32 v5, v5
  v_mov_b32 v30, v4
  v_mul_f32 v28, v28, v5
  v_sub_f32 v32, v32, v4
  v_sub_f32 v33, v33, v4
  v_sub_f32 v34, v34, v4
  v_sub_f32 v35, v35, v4
  v_sub_f32 v36, v36, v4
  v_sub_f32 v37, v37, v4
  v_sub_f32 v38, v38, v4
  v_sub_f32 v39, v39, v4
  v_sub_f32 v40, v40, v4
  v_sub_f32 v41, v41, v4
  v_sub_f32 v42, v42, v4
  v_sub_f32 v43, v43, v4
  v_sub_f32 v44, v44, v4
  v_sub_f32 v45, v45, v4
  v_sub_f32 v46, v46, v4
  v_sub_f32 v47, v47, v4
  v_exp_f32 v32, v32
  v_exp_f32 v33, v33
  v_exp_f32 v34, v34
  v_exp_f32 v35, v35
  v_exp_f32 v36, v36
  v_exp_f32 v37, v37
  v_exp_f32 v38, v38
  v_exp_f32 v39, v39
  v_exp_f32 v40, v40
  v_exp_f32 v41, v41
  v_exp_f32 v42, v42
  v_exp_f32 v43, v43
  v_exp_f32 v44, v44
  v_exp_f32 v45, v45
  v_exp_f32 v46, v46
  v_exp_f32 v47, v47
  s_nop 0
  v_add_f32 v28, v28, v32
  v_add_f32 v28, v28, v33
  v_add_f32 v28, v28, v34
  v_add_f32 v28, v28, v35
  v_add_f32 v28, v28, v36
  v_add_f32 v28, v28, v37
  v_add_f32 v28, v28, v38
  v_add_f32 v28, v28, v39
  v_add_f32 v28, v28, v40
  v_add_f32 v28, v28, v41
  v_add_f32 v28, v28, v42
  v_add_f32 v28, v28, v43
  v_add_f32 v28, v28, v44
  v_add_f32 v28, v28, v45
  v_add_f32 v28, v28, v46
  v_add_f32 v28, v28, v47
  v_cvt_pk_bf16_f32 v96, v32, v33
  v_cvt_pk_bf16_f32 v97, v34, v35
  v_cvt_pk_bf16_f32 v98, v36, v37
  v_cvt_pk_bf16_f32 v99, v38, v39
  v_cvt_pk_bf16_f32 v100, v40, v41
  v_cvt_pk_bf16_f32 v101, v42, v43
  v_cvt_pk_bf16_f32 v102, v44, v45
  v_cvt_pk_bf16_f32 v103, v46, v47
  v_mul_f32 v160, v160, v5
  v_mul_f32 v161, v161, v5
  v_mul_f32 v162, v162, v5
  v_mul_f32 v163, v163, v5
  v_mul_f32 v164, v164, v5
  v_mul_f32 v165, v165, v5
  v_mul_f32 v166, v166, v5
  v_mul_f32 v167, v167, v5
  v_mul_f32 v168, v168, v5
  v_mul_f32 v169, v169, v5
  v_mul_f32 v170, v170, v5
  v_mul_f32 v171, v171, v5
  v_mul_f32 v172, v172, v5
  v_mul_f32 v173, v173, v5
  v_mul_f32 v174, v174, v5
  v_mul_f32 v175, v175, v5
  v_mul_f32 v176, v176, v5
  v_mul_f32 v177, v177, v5
  v_mul_f32 v178, v178, v5
  v_mul_f32 v179, v179, v5
  v_mul_f32 v180, v180, v5
  v_mul_f32 v181, v181, v5
  v_mul_f32 v182, v182, v5
  v_mul_f32 v183, v183, v5
  v_mul_f32 v184, v184, v5
  v_mul_f32 v185, v185, v5
  v_mul_f32 v186, v186, v5
  v_mul_f32 v187, v187, v5
  v_mul_f32 v188, v188, v5
  v_mul_f32 v189, v189, v5
  v_mul_f32 v190, v190, v5
  v_mul_f32 v191, v191, v5
  v_mul_f32 v192, v192, v5
  v_mul_f32 v193, v193, v5
  v_mul_f32 v194, v194, v5
  v_mul_f32 v195, v195, v5
  v_mul_f32 v196, v196, v5
  v_mul_f32 v197, v197, v5
  v_mul_f32 v198, v198, v5
  v_mul_f32 v199, v199, v5
  v_mul_f32 v200, v200, v5
  v_mul_f32 v201, v201, v5
  v_mul_f32 v202, v202, v5
  v_mul_f32 v203, v203, v5
  v_mul_f32 v204, v204, v5
  v_mul_f32 v205, v205, v5
  v_mul_f32 v206, v206, v5
  v_mul_f32 v207, v207, v5
  v_mul_f32 v208, v208, v5
  v_mul_f32 v209, v209, v5
  v_mul_f32 v210, v210, v5
  v_mul_f32 v211, v211, v5
  v_mul_f32 v212, v212, v5
  v_mul_f32 v213, v213, v5
  v_mul_f32 v214, v214, v5
  v_mul_f32 v215, v215, v5
  v_mul_f32 v216, v216, v5
  v_mul_f32 v217, v217, v5
  v_mul_f32 v218, v218, v5
  v_mul_f32 v219, v219, v5
  v_mul_f32 v220, v220, v5
  v_mul_f32 v221, v221, v5
  v_mul_f32 v222, v222, v5
  v_mul_f32 v223, v223, v5
  v_max3_f32 v4, v48, v49, v50
  v_max3_f32 v4, v4, v51, v52
  v_max3_f32 v4, v4, v53, v54
  v_max3_f32 v4, v4, v55, v56
  v_max3_f32 v4, v4, v57, v58
  v_max3_f32 v4, v4, v59, v60
  v_max3_f32 v4, v4, v61, v62
  v_max_f32 v4, v4, v63
  v_mov_b32 v5, v4
  s_nop 1
  v_permlane32_swap_b32 v4, v5
  s_nop 1
  v_max3_f32 v4, v4, v5, v31
  v_sub_f32 v5, v31, v4
  v_exp_f32 v5, v5
  v_mov_b32 v31, v4
  v_mul_f32 v29, v29, v5
  v_sub_f32 v48, v48, v4
  v_sub_f32 v49, v49, v4
  v_sub_f32 v50, v50, v4
  v_sub_f32 v51, v51, v4
  v_sub_f32 v52, v52, v4
  v_sub_f32 v53, v53, v4
  v_sub_f32 v54, v54, v4
  v_sub_f32 v55, v55, v4
  v_sub_f32 v56, v56, v4
  v_sub_f32 v57, v57, v4
  v_sub_f32 v58, v58, v4
  v_sub_f32 v59, v59, v4
  v_sub_f32 v60, v60, v4
  v_sub_f32 v61, v61, v4
  v_sub_f32 v62, v62, v4
  v_sub_f32 v63, v63, v4
  v_exp_f32 v48, v48
  v_exp_f32 v49, v49
  v_exp_f32 v50, v50
  v_exp_f32 v51, v51
  v_exp_f32 v52, v52
  v_exp_f32 v53, v53
  v_exp_f32 v54, v54
  v_exp_f32 v55, v55
  v_exp_f32 v56, v56
  v_exp_f32 v57, v57
  v_exp_f32 v58, v58
  v_exp_f32 v59, v59
  v_exp_f32 v60, v60
  v_exp_f32 v61, v61
  v_exp_f32 v62, v62
  v_exp_f32 v63, v63
  s_nop 0
  v_add_f32 v29, v29, v48
  v_add_f32 v29, v29, v49
  v_add_f32 v29, v29, v50
  v_add_f32 v29, v29, v51
  v_add_f32 v29, v29, v52
  v_add_f32 v29, v29, v53
  v_add_f32 v29, v29, v54
  v_add_f32 v29, v29, v55
  v_add_f32 v29, v29, v56
  v_add_f32 v29, v29, v57
  v_add_f32 v29, v29, v58
  v_add_f32 v29, v29, v59
  v_add_f32 v29, v29, v60
  v_add_f32 v29, v29, v61
  v_add_f32 v29, v29, v62
  v_add_f32 v29, v29, v63
  v_cvt_pk_bf16_f32 v104, v48, v49
  v_cvt_pk_bf16_f32 v105, v50, v51
  v_cvt_pk_bf16_f32 v106, v52, v53
  v_cvt_pk_bf16_f32 v107, v54, v55
  v_cvt_pk_bf16_f32 v108, v56, v57
  v_cvt_pk_bf16_f32 v109, v58, v59
  v_cvt_pk_bf16_f32 v110, v60, v61
  v_cvt_pk_bf16_f32 v111, v62, v63
  v_accvgpr_read_b32 v6, a0
  v_mul_f32 v6, v6, v5
  v_accvgpr_write_b32 a0, v6
  v_accvgpr_read_b32 v6, a1
  v_mul_f32 v6, v6, v5
  v_accvgpr_write_b32 a1, v6
  v_accvgpr_read_b32 v6, a2
  v_mul_f32 v6, v6, v5
  v_accvgpr_write_b32 a2, v6
  v_accvgpr_read_b32 v6, a3
  v_mul_f32 v6, v6, v5
  v_accvgpr_write_b32 a3, v6
  v_accvgpr_read_b32 v6, a4
  v_mul_f32 v6, v6, v5
  v_accvgpr_write_b32 a4, v6
  v_accvgpr_read_b32 v6, a5
  v_mul_f32 v6, v6, v5
  v_accvgpr_write_b32 a5, v6
  v_accvgpr_read_b32 v6, a6
  v_mul_f32 v6, v6, v5
  v_accvgpr_write_b32 a6, v6
  v_accvgpr_read_b32 v6, a7
  v_mul_f32 v6, v6, v5
  v_accvgpr_write_b32 a7, v6
  v_accvgpr_read_b32 v6, a8
  v_mul_f32 v6, v6, v5
  v_accvgpr_write_b32 a8, v6
  v_accvgpr_read_b32 v6, a9
  v_mul_f32 v6, v6, v5
  v_accvgpr_write_b32 a9, v6
  v_accvgpr_read_b32 v6, a10
  v_mul_f32 v6, v6, v5
  v_accvgpr_write_b32 a10, v6
  v_accvgpr_read_b32 v6, a11
  v_mul_f32 v6, v6, v5
  v_accvgpr_write_b32 a11, v6
  v_accvgpr_read_b32 v6, a12
  v_mul_f32 v6, v6, v5
  v_accvgpr_write_b32 a12, v6
  v_accvgpr_read_b32 v6, a13
  v_mul_f32 v6, v6, v5
  v_accvgpr_write_b32 a13, v6
  v_accvgpr_read_b32 v6, a14
  v_mul_f32 v6, v6, v5
  v_accvgpr_write_b32 a14, v6
  v_accvgpr_read_b32 v6, a15
  v_mul_f32 v6, v6, v5
  v_accvgpr_write_b32 a15, v6
  v_accvgpr_read_b32 v6, a16
  v_mul_f32 v6, v6, v5
  v_accvgpr_write_b32 a16, v6
  v_accvgpr_read_b32 v6, a17
  v_mul_f32 v6, v6, v5
  v_accvgpr_write_b32 a17, v6
  v_accvgpr_read_b32 v6, a18
  v_mul_f32 v6, v6, v5
  v_accvgpr_write_b32 a18, v6
  v_accvgpr_read_b32 v6, a19
  v_mul_f32 v6, v6, v5
  v_accvgpr_write_b32 a19, v6
  v_accvgpr_read_b32 v6, a20
  v_mul_f32 v6, v6, v5
  v_accvgpr_write_b32 a20, v6
  v_accvgpr_read_b32 v6, a21
  v_mul_f32 v6, v6, v5
  v_accvgpr_write_b32 a21, v6
  v_accvgpr_read_b32 v6, a22
  v_mul_f32 v6, v6, v5
  v_accvgpr_write_b32 a22, v6
  v_accvgpr_read_b32 v6, a23
  v_mul_f32 v6, v6, v5
  v_accvgpr_write_b32 a23, v6
  v_accvgpr_read_b32 v6, a24
  v_mul_f32 v6, v6, v5
  v_accvgpr_write_b32 a24, v6
  v_accvgpr_read_b32 v6, a25
  v_mul_f32 v6, v6, v5
  v_accvgpr_write_b32 a25, v6
  v_accvgpr_read_b32 v6, a26
  v_mul_f32 v6, v6, v5
  v_accvgpr_write_b32 a26, v6
  v_accvgpr_read_b32 v6, a27
  v_mul_f32 v6, v6, v5
  v_accvgpr_write_b32 a27, v6
  v_accvgpr_read_b32 v6, a28
  v_mul_f32 v6, v6, v5
  v_accvgpr_write_b32 a28, v6
  v_accvgpr_read_b32 v6, a29
  v_mul_f32 v6, v6, v5
  v_accvgpr_write_b32 a29, v6
  v_accvgpr_read_b32 v6, a30
  v_mul_f32 v6, v6, v5
  v_accvgpr_write_b32 a30, v6
  v_accvgpr_read_b32 v6, a31
  v_mul_f32 v6, v6, v5
  v_accvgpr_write_b32 a31, v6
  v_accvgpr_read_b32 v6, a32
  v_mul_f32 v6, v6, v5
  v_accvgpr_write_b32 a32, v6
  v_accvgpr_read_b32 v6, a33
  v_mul_f32 v6, v6, v5
  v_accvgpr_write_b32 a33, v6
  v_accvgpr_read_b32 v6, a34
  v_mul_f32 v6, v6, v5
  v_accvgpr_write_b32 a34, v6
  v_accvgpr_read_b32 v6, a35
  v_mul_f32 v6, v6, v5
  v_accvgpr_write_b32 a35, v6
  v_accvgpr_read_b32 v6, a36
  v_mul_f32 v6, v6, v5
  v_accvgpr_write_b32 a36, v6
  v_accvgpr_read_b32 v6, a37
  v_mul_f32 v6, v6, v5
  v_accvgpr_write_b32 a37, v6
  v_accvgpr_read_b32 v6, a38
  v_mul_f32 v6, v6, v5
  v_accvgpr_write_b32 a38, v6
  v_accvgpr_read_b32 v6, a39
  v_mul_f32 v6, v6, v5
  v_accvgpr_write_b32 a39, v6
  v_accvgpr_read_b32 v6, a40
  v_mul_f32 v6, v6, v5
  v_accvgpr_write_b32 a40, v6
  v_accvgpr_read_b32 v6, a41
  v_mul_f32 v6, v6, v5
  v_accvgpr_write_b32 a41, v6
  v_accvgpr_read_b32 v6, a42
  v_mul_f32 v6, v6, v5
  v_accvgpr_write_b32 a42, v6
  v_accvgpr_read_b32 v6, a43
  v_mul_f32 v6, v6, v5
  v_accvgpr_write_b32 a43, v6
  v_accvgpr_read_b32 v6, a44
  v_mul_f32 v6, v6, v5
  v_accvgpr_write_b32 a44, v6
  v_accvgpr_read_b32 v6, a45
  v_mul_f32 v6, v6, v5
  v_accvgpr_write_b32 a45, v6
  v_accvgpr_read_b32 v6, a46
  v_mul_f32 v6, v6, v5
  v_accvgpr_write_b32 a46, v6
  v_accvgpr_read_b32 v6, a47
  v_mul_f32 v6, v6, v5
  v_accvgpr_write_b32 a47, v6
  v_accvgpr_read_b32 v6, a48
  v_mul_f32 v6, v6, v5
  v_accvgpr_write_b32 a48, v6
  v_accvgpr_read_b32 v6, a49
  v_mul_f32 v6, v6, v5
  v_accvgpr_write_b32 a49, v6
  v_accvgpr_read_b32 v6, a50
  v_mul_f32 v6, v6, v5
  v_accvgpr_write_b32 a50, v6
  v_accvgpr_read_b32 v6, a51
  v_mul_f32 v6, v6, v5
  v_accvgpr_write_b32 a51, v6
  v_accvgpr_read_b32 v6, a52
  v_mul_f32 v6, v6, v5
  v_accvgpr_write_b32 a52, v6
  v_accvgpr_read_b32 v6, a53
  v_mul_f32 v6, v6, v5
  v_accvgpr_write_b32 a53, v6
  v_accvgpr_read_b32 v6, a54
  v_mul_f32 v6, v6, v5
  v_accvgpr_write_b32 a54, v6
  v_accvgpr_read_b32 v6, a55
  v_mul_f32 v6, v6, v5
  v_accvgpr_write_b32 a55, v6
  v_accvgpr_read_b32 v6, a56
  v_mul_f32 v6, v6, v5
  v_accvgpr_write_b32 a56, v6
  v_accvgpr_read_b32 v6, a57
  v_mul_f32 v6, v6, v5
  v_accvgpr_write_b32 a57, v6
  v_accvgpr_read_b32 v6, a58
  v_mul_f32 v6, v6, v5
  v_accvgpr_write_b32 a58, v6
  v_accvgpr_read_b32 v6, a59
  v_mul_f32 v6, v6, v5
  v_accvgpr_write_b32 a59, v6
  v_accvgpr_read_b32 v6, a60
  v_mul_f32 v6, v6, v5
  v_accvgpr_write_b32 a60, v6
  v_accvgpr_read_b32 v6, a61
  v_mul_f32 v6, v6, v5
  v_accvgpr_write_b32 a61, v6
  v_accvgpr_read_b32 v6, a62
  v_mul_f32 v6, v6, v5
  v_accvgpr_write_b32 a62, v6
  v_accvgpr_read_b32 v6, a63
  v_mul_f32 v6, v6, v5
  v_accvgpr_write_b32 a63, v6
  s_nop 1
  v_mfma_f32_32x32x16_bf16 v[160:175], a[224:227], v[96:99], v[160:175]
  v_mfma_f32_32x32x16_bf16 v[176:191], a[232:235], v[96:99], v[176:191]
  v_mfma_f32_32x32x16_bf16 v[192:207], a[240:243], v[96:99], v[192:207]
  v_mfma_f32_32x32x16_bf16 v[208:223], a[248:251], v[96:99], v[208:223]
  v_mfma_f32_32x32x16_bf16 v[160:175], a[228:231], v[100:103], v[160:175]
  v_mfma_f32_32x32x16_bf16 v[176:191], a[236:239], v[100:103], v[176:191]
  v_mfma_f32_32x32x16_bf16 v[192:207], a[244:247], v[100:103], v[192:207]
  v_mfma_f32_32x32x16_bf16 v[208:223], a[252:255], v[100:103], v[208:223]
  v_mfma_f32_32x32x16_bf16 a[0:15], a[224:227], v[104:107], a[0:15]
  v_mfma_f32_32x32x16_bf16 a[16:31], a[232:235], v[104:107], a[16:31]
  v_mfma_f32_32x32x16_bf16 a[32:47], a[240:243], v[104:107], a[32:47]
  v_mfma_f32_32x32x16_bf16 a[48:63], a[248:251], v[104:107], a[48:63]
  v_mfma_f32_32x32x16_bf16 a[0:15], a[228:231], v[108:111], a[0:15]
  v_mfma_f32_32x32x16_bf16 a[16:31], a[236:239], v[108:111], a[16:31]
  v_mfma_f32_32x32x16_bf16 a[32:47], a[244:247], v[108:111], a[32:47]
  v_mfma_f32_32x32x16_bf16 a[48:63], a[252:255], v[108:111], a[48:63]
  s_add_u32 s7, s7, 8192
  s_cmp_lt_u32 s7, 131072
  s_nop 15
  s_cbranch_scc1 L_safe_loop
  v_mov_b32 v4, v28
  s_nop 1
  v_permlane32_swap_b32 v28, v4
  s_nop 1
  v_add_f32 v28, v28, v4
  v_mov_b32 v4, v29
  s_nop 1
  v_permlane32_swap_b32 v29, v4
  s_nop 1
  v_add_f32 v29, v29, v4
  s_nop 7
  s_barrier
  v_add_u32 v8, 0x1a000, v14
  v_cvt_pk_bf16_f32 v32, v160, v161
  v_cvt_pk_bf16_f32 v33, v162, v163
  v_cvt_pk_bf16_f32 v34, v164, v165
  v_cvt_pk_bf16_f32 v35, v166, v167
  v_cvt_pk_bf16_f32 v36, v168, v169
  v_cvt_pk_bf16_f32 v37, v170, v171
  v_cvt_pk_bf16_f32 v38, v172, v173
  v_cvt_pk_bf16_f32 v39, v174, v175
  v_cvt_pk_bf16_f32 v40, v176, v177
  v_cvt_pk_bf16_f32 v41, v178, v179
  v_cvt_pk_bf16_f32 v42, v180, v181
  v_cvt_pk_bf16_f32 v43, v182, v183
  v_cvt_pk_bf16_f32 v44, v184, v185
  v_cvt_pk_bf16_f32 v45, v186, v187
  v_cvt_pk_bf16_f32 v46, v188, v189
  v_cvt_pk_bf16_f32 v47, v190, v191
  v_cvt_pk_bf16_f32 v48, v192, v193
  v_cvt_pk_bf16_f32 v49, v194, v195
  v_cvt_pk_bf16_f32 v50, v196, v197
  v_cvt_pk_bf16_f32 v51, v198, v199
  v_cvt_pk_bf16_f32 v52, v200, v201
  v_cvt_pk_bf16_f32 v53, v202, v203
  v_cvt_pk_bf16_f32 v54, v204, v205
  v_cvt_pk_bf16_f32 v55, v206, v207
  v_cvt_pk_bf16_f32 v56, v208, v209
  v_cvt_pk_bf16_f32 v57, v210, v211
  v_cvt_pk_bf16_f32 v58, v212, v213
  v_cvt_pk_bf16_f32 v59, v214, v215
  v_cvt_pk_bf16_f32 v60, v216, v217
  v_cvt_pk_bf16_f32 v61, v218, v219
  v_cvt_pk_bf16_f32 v62, v220, v221
  v_cvt_pk_bf16_f32 v63, v222, v223
  s_nop 0
  s_cmp_eq_u32 s76, 1
  s_cbranch_scc1 L_pg_73
  s_cmp_eq_u32 s76, 2
  s_cbranch_scc1 L_pl_74
  s_add_u32 s68, s77, 0
  buffer_store_dwordx4 v[32:35], v14, s[52:55], s68 offen
  s_add_u32 s68, s77, 1024
  buffer_store_dwordx4 v[36:39], v14, s[52:55], s68 offen
  s_add_u32 s68, s77, 2048
  buffer_store_dwordx4 v[40:43], v14, s[52:55], s68 offen
  s_add_u32 s68, s77, 3072
  buffer_store_dwordx4 v[44:47], v14, s[52:55], s68 offen
  s_add_u32 s68, s77, 4096
  buffer_store_dwordx4 v[48:51], v14, s[52:55], s68 offen
  s_add_u32 s68, s77, 5120
  buffer_store_dwordx4 v[52:55], v14, s[52:55], s68 offen
  s_add_u32 s68, s77, 6144
  buffer_store_dwordx4 v[56:59], v14, s[52:55], s68 offen
  s_add_u32 s68, s77, 7168
  buffer_store_dwordx4 v[60:63], v14, s[52:55], s68 offen
  s_branch L_pe_75
L_pg_73:
  s_add_u32 s68, s77, 0
  buffer_store_dwordx4 v[32:35], v14, s[52:55], s68 offen sc0 sc1
  s_add_u32 s68, s77, 1024
  buffer_store_dwordx4 v[36:39], v14, s[52:55], s68 offen sc0 sc1
  s_add_u32 s68, s77, 2048
  buffer_store_dwordx4 v[40:43], v14, s[52:55], s68 offen sc0 sc1
  s_add_u32 s68, s77, 3072
  buffer_store_dwordx4 v[44:47], v14, s[52:55], s68 offen sc0 sc1
  s_add_u32 s68, s77, 4096
  buffer_store_dwordx4 v[48:51], v14, s[52:55], s68 offen sc0 sc1
  s_add_u32 s68, s77, 5120
  buffer_store_dwordx4 v[52:55], v14, s[52:55], s68 offen sc0 sc1
  s_add_u32 s68, s77, 6144
  buffer_store_dwordx4 v[56:59], v14, s[52:55], s68 offen sc0 sc1
  s_add_u32 s68, s77, 7168
  buffer_store_dwordx4 v[60:63], v14, s[52:55], s68 offen sc0 sc1
  s_branch L_pe_75
L_pl_74:
  ds_write_b128 v8, v[32:35] offset:0
  ds_write_b128 v8, v[36:39] offset:1024
  ds_write_b128 v8, v[40:43] offset:2048
  ds_write_b128 v8, v[44:47] offset:3072
  ds_write_b128 v8, v[48:51] offset:4096
  ds_write_b128 v8, v[52:55] offset:5120
  ds_write_b128 v8, v[56:59] offset:6144
  ds_write_b128 v8, v[60:63] offset:7168
L_pe_75:
  v_accvgpr_read_b32 v96, a0
  v_accvgpr_read_b32 v97, a1
  v_accvgpr_read_b32 v98, a2
  v_accvgpr_read_b32 v99, a3
  v_accvgpr_read_b32 v100, a4
  v_accvgpr_read_b32 v101, a5
  v_accvgpr_read_b32 v102, a6
  v_accvgpr_read_b32 v103, a7
  v_accvgpr_read_b32 v104, a8
  v_accvgpr_read_b32 v105, a9
  v_accvgpr_read_b32 v106, a10
  v_accvgpr_read_b32 v107, a11
  v_accvgpr_read_b32 v108, a12
  v_accvgpr_read_b32 v109, a13
  v_accvgpr_read_b32 v110, a14
  v_accvgpr_read_b32 v111, a15
  v_cvt_pk_bf16_f32 v64, v96, v97
  v_cvt_pk_bf16_f32 v65, v98, v99
  v_cvt_pk_bf16_f32 v66, v100, v101
  v_cvt_pk_bf16_f32 v67, v102, v103
  v_cvt_pk_bf16_f32 v68, v104, v105
  v_cvt_pk_bf16_f32 v69, v106, v107
  v_cvt_pk_bf16_f32 v70, v108, v109
  v_cvt_pk_bf16_f32 v71, v110, v111
  s_nop 0
  s_cmp_eq_u32 s76, 1
  s_cbranch_scc1 L_pg_76
  s_cmp_eq_u32 s76, 2
  s_cbranch_scc1 L_pl_77
  s_add_u32 s68, s77, 8192
  buffer_store_dwordx4 v[64:67], v14, s[52:55], s68 offen
  s_add_u32 s68, s77, 9216
  buffer_store_dwordx4 v[68:71], v14, s[52:55], s68 offen
  s_branch L_pe_78
L_pg_76:
  s_add_u32 s68, s77, 8192
  buffer_store_dwordx4 v[64:67], v14, s[52:55], s68 offen sc0 sc1
  s_add_u32 s68, s77, 9216
  buffer_store_dwordx4 v[68:71], v14, s[52:55], s68 offen sc0 sc1
  s_branch L_pe_78
L_pl_77:
  ds_write_b128 v8, v[64:67] offset:8192
  ds_write_b128 v8, v[68:71] offset:9216
L_pe_78:
  v_accvgpr_read_b32 v96, a16
  v_accvgpr_read_b32 v97, a17
  v_accvgpr_read_b32 v98, a18
  v_accvgpr_read_b32 v99, a19
  v_accvgpr_read_b32 v100, a20
  v_accvgpr_read_b32 v101, a21
  v_accvgpr_read_b32 v102, a22
  v_accvgpr_read_b32 v103, a23
  v_accvgpr_read_b32 v104, a24
  v_accvgpr_read_b32 v105, a25
  v_accvgpr_read_b32 v106, a26
  v_accvgpr_read_b32 v107, a27
  v_accvgpr_read_b32 v108, a28
  v_accvgpr_read_b32 v109, a29
  v_accvgpr_read_b32 v110, a30
  v_accvgpr_read_b32 v111, a31
  v_cvt_pk_bf16_f32 v72, v96, v97
  v_cvt_pk_bf16_f32 v73, v98, v99
  v_cvt_pk_bf16_f32 v74, v100, v101
  v_cvt_pk_bf16_f32 v75, v102, v103
  v_cvt_pk_bf16_f32 v76, v104, v105
  v_cvt_pk_bf16_f32 v77, v106, v107
  v_cvt_pk_bf16_f32 v78, v108, v109
  v_cvt_pk_bf16_f32 v79, v110, v111
  s_nop 0
  s_cmp_eq_u32 s76, 1
  s_cbranch_scc1 L_pg_79
  s_cmp_eq_u32 s76, 2
  s_cbranch_scc1 L_pl_80
  s_add_u32 s68, s77, 10240
  buffer_store_dwordx4 v[72:75], v14, s[52:55], s68 offen
  s_add_u32 s68, s77, 11264
  buffer_store_dwordx4 v[76:79], v14, s[52:55], s68 offen
  s_branch L_pe_81
L_pg_79:
  s_add_u32 s68, s77, 10240
  buffer_store_dwordx4 v[72:75], v14, s[52:55], s68 offen sc0 sc1
  s_add_u32 s68, s77, 11264
  buffer_store_dwordx4 v[76:79], v14, s[52:55], s68 offen sc0 sc1
  s_branch L_pe_81
L_pl_80:
  ds_write_b128 v8, v[72:75] offset:10240
  ds_write_b128 v8, v[76:79] offset:11264
L_pe_81:
  v_accvgpr_read_b32 v96, a32
  v_accvgpr_read_b32 v97, a33
  v_accvgpr_read_b32 v98, a34
  v_accvgpr_read_b32 v99, a35
  v_accvgpr_read_b32 v100, a36
  v_accvgpr_read_b32 v101, a37
  v_accvgpr_read_b32 v102, a38
  v_accvgpr_read_b32 v103, a39
  v_accvgpr_read_b32 v104, a40
  v_accvgpr_read_b32 v105, a41
  v_accvgpr_read_b32 v106, a42
  v_accvgpr_read_b32 v107, a43
  v_accvgpr_read_b32 v108, a44
  v_accvgpr_read_b32 v109, a45
  v_accvgpr_read_b32 v110, a46
  v_accvgpr_read_b32 v111, a47
  v_cvt_pk_bf16_f32 v80, v96, v97
  v_cvt_pk_bf16_f32 v81, v98, v99
  v_cvt_pk_bf16_f32 v82, v100, v101
  v_cvt_pk_bf16_f32 v83, v102, v103
  v_cvt_pk_bf16_f32 v84, v104, v105
  v_cvt_pk_bf16_f32 v85, v106, v107
  v_cvt_pk_bf16_f32 v86, v108, v109
  v_cvt_pk_bf16_f32 v87, v110, v111
  s_nop 0
  s_cmp_eq_u32 s76, 1
  s_cbranch_scc1 L_pg_82
  s_cmp_eq_u32 s76, 2
  s_cbranch_scc1 L_pl_83
  s_add_u32 s68, s77, 12288
  buffer_store_dwordx4 v[80:83], v14, s[52:55], s68 offen
  s_add_u32 s68, s77, 13312
  buffer_store_dwordx4 v[84:87], v14, s[52:55], s68 offen
  s_branch L_pe_84
L_pg_82:
  s_add_u32 s68, s77, 12288
  buffer_store_dwordx4 v[80:83], v14, s[52:55], s68 offen sc0 sc1
  s_add_u32 s68, s77, 13312
  buffer_store_dwordx4 v[84:87], v14, s[52:55], s68 offen sc0 sc1
  s_branch L_pe_84
L_pl_83:
  ds_write_b128 v8, v[80:83] offset:12288
  ds_write_b128 v8, v[84:87] offset:13312
L_pe_84:
  v_accvgpr_read_b32 v96, a48
  v_accvgpr_read_b32 v97, a49
  v_accvgpr_read_b32 v98, a50
  v_accvgpr_read_b32 v99, a51
  v_accvgpr_read_b32 v100, a52
  v_accvgpr_read_b32 v101, a53
  v_accvgpr_read_b32 v102, a54
  v_accvgpr_read_b32 v103, a55
  v_accvgpr_read_b32 v104, a56
  v_accvgpr_read_b32 v105, a57
  v_accvgpr_read_b32 v106, a58
  v_accvgpr_read_b32 v107, a59
  v_accvgpr_read_b32 v108, a60
  v_accvgpr_read_b32 v109, a61
  v_accvgpr_read_b32 v110, a62
  v_accvgpr_read_b32 v111, a63
  v_cvt_pk_bf16_f32 v88, v96, v97
  v_cvt_pk_bf16_f32 v89, v98, v99
  v_cvt_pk_bf16_f32 v90, v100, v101
  v_cvt_pk_bf16_f32 v91, v102, v103
  v_cvt_pk_bf16_f32 v92, v104, v105
  v_cvt_pk_bf16_f32 v93, v106, v107
  v_cvt_pk_bf16_f32 v94, v108, v109
  v_cvt_pk_bf16_f32 v95, v110, v111
  s_nop 0
  s_cmp_eq_u32 s76, 1
  s_cbranch_scc1 L_pg_85
  s_cmp_eq_u32 s76, 2
  s_cbranch_scc1 L_pl_86
  s_add_u32 s68, s77, 14336
  buffer_store_dwordx4 v[88:91], v14, s[52:55], s68 offen
  s_add_u32 s68, s77, 15360
  buffer_store_dwordx4 v[92:95], v14, s[52:55], s68 offen
  s_branch L_pe_87
L_pg_85:
  s_add_u32 s68, s77, 14336
  buffer_store_dwordx4 v[88:91], v14, s[52:55], s68 offen sc0 sc1
  s_add_u32 s68, s77, 15360
  buffer_store_dwordx4 v[92:95], v14, s[52:55], s68 offen sc0 sc1
  s_branch L_pe_87
L_pl_86:
  ds_write_b128 v8, v[88:91] offset:14336
  ds_write_b128 v8, v[92:95] offset:15360
L_pe_87:
  v_mov_b32 v4, v30
  v_mov_b32 v5, v28
  v_mov_b32 v6, v31
  v_mov_b32 v7, v29
  s_cmp_eq_u32 s9, 0
  s_cbranch_scc1 L_sg_88
  s_mov_b32 exec_hi, 0
  buffer_store_dwordx4 v[4:7], v14, s[52:55], s78 offen
  s_mov_b32 exec_hi, -1
  s_branch L_se_89
L_sg_88:
  s_mov_b32 exec_hi, 0
  buffer_store_dwordx4 v[4:7], v14, s[52:55], s78 offen sc0 sc1
  s_mov_b32 exec_hi, -1
L_se_89:
  s_lshl_b32 s66, s11, 9
  s_lshl_b32 s67, s3, 7
  s_add_u32 s67, s67, s66
  s_lshl_b32 s68, s6, 2
  s_add_u32 s67, s67, s68
  s_add_u32 s67, s67, 34619392
  s_branch L_safe_back
.section .rodata,"a"
.p2align 6
.amdhsa_kernel standalone__gqa_block_cached__near_ridge_kernel
  .amdhsa_next_free_vgpr 512
  .amdhsa_next_free_sgpr 102
  .amdhsa_accum_offset 256
  .amdhsa_group_segment_fixed_size 0
  .amdhsa_kernarg_size 64
  .amdhsa_user_sgpr_count 2
  .amdhsa_user_sgpr_kernarg_segment_ptr 1
  .amdhsa_system_sgpr_workgroup_id_x 1
  .amdhsa_float_denorm_mode_32 3
.end_amdhsa_kernel
```
